```python
import torch

def _softmax(x, axis=-1):
    return torch.softmax(x, dim=axis)
def _gelu(x):
    return torch.nn.functional.gelu(x, approximate="tanh")
def _silu(x):
    return torch.nn.functional.silu(x)
def _sigmoid(x):
    return torch.sigmoid(x)
def _layernorm(x, axis=-1, eps=1e-5):
    m = x.mean(dim=axis, keepdim=True)
    v = x.var(dim=axis, keepdim=True, unbiased=False)
    return (x - m) / torch.sqrt(v + eps)
def _scatter_add(tgt, idx, src, axis=0):
    return tgt.clone().index_add_(axis, idx, src)
def _segment_sum(src, seg, n):
    out = torch.zeros((n,) + src.shape[1:], dtype=src.dtype)
    return out.index_add_(0, seg, src)
def _pad(x, pw):
    flat = tuple(v for pair in reversed(pw) for v in pair)
    return torch.nn.functional.pad(x, flat)

kernel_name = 'gated_mix__spectral_fnet__sliding_local_dilated__prompt'

def setup_inputs():

    _w = (lambda a: (lambda t: t.to(torch.bfloat16) if t.is_floating_point() else t)(torch.as_tensor(a)))
    def _A_setup():
        B, S, D = 1, 2048, 512
        ns = torch.arange(S)[:, None] * torch.arange(S)[None, :]
        nd = torch.arange(D)[:, None] * torch.arange(D)[None, :]
        Ws_re = torch.cos(-2.0 * torch.pi * ns / S).to(float)
        Ws_im = torch.sin(-2.0 * torch.pi * ns / S).to(float)
        Wd_re = torch.cos(-2.0 * torch.pi * nd / D).to(float)
        Wd_im = torch.sin(-2.0 * torch.pi * nd / D).to(float)
        return {
            "x": _w((lambda *s: torch.randn(*s, dtype=torch.bfloat16) * 0.05)(B, S, D)),
            "dft_seq_re": _w(Ws_re),
            "dft_seq_im": _w(Ws_im),
            "dft_hid_re": _w(Wd_re),
            "dft_hid_im": _w(Wd_im),
        }
    _A_in = _A_setup()

    def _B_setup():
        B, S, D = 1, 2048, 512
        return {
            "x": _w((lambda *s: torch.randn(*s, dtype=torch.bfloat16) * 0.05)(B, S, D)),
            "wqkv": _w((lambda *s: torch.randn(*s, dtype=torch.bfloat16) * 1.6)(D, 3 * D)),
            "wo": _w((lambda *s: torch.randn(*s, dtype=torch.bfloat16) * 0.2)(D, D)),
        }
    _B_in = _B_setup()

    return {
        "A_x": _A_in["x"],
        "A_dft_seq_re": _A_in["dft_seq_re"],
        "A_dft_seq_im": _A_in["dft_seq_im"],
        "A_dft_hid_re": _A_in["dft_hid_re"],
        "A_dft_hid_im": _A_in["dft_hid_im"],
        "B_x": _B_in["x"],
        "B_wqkv": _B_in["wqkv"],
        "B_wo": _B_in["wo"],
        "gate_w": _w((lambda *s: torch.randn(*s, dtype=torch.bfloat16) * 0.05)(512) * 16.0),
    }

def reference(A_x, A_dft_seq_re, A_dft_seq_im, A_dft_hid_re, A_dft_hid_im, B_x, B_wqkv, B_wo, gate_w):
    def _A_ref(x, dft_seq_re, dft_seq_im, dft_hid_re, dft_hid_im):
        a = torch.einsum("bsd,ed->bse", x, dft_hid_re)
        b = torch.einsum("bsd,ed->bse", x, dft_hid_im)
        y = torch.einsum("ts,bse->bte", dft_seq_re, a) - torch.einsum("ts,bse->bte", dft_seq_im, b)
        return y

    def _B_ref(x, wqkv, wo):
        B, S, D = x.shape
        H = 32; Dh = D // H
        W, dil = 8, 2
        qkv = (lambda x, *d: x.permute(*d))((x @ wqkv).reshape(B, S, 3, H, Dh), 2, 0, 3, 1, 4)
        q, k, v = qkv[0], qkv[1], qkv[2]
        scale = Dh ** -0.5
        pos = torch.arange(S)
        off = torch.arange(W) * dil
        idx = pos[:, None] - off[None, :]
        mask = idx >= 0
        idx_c = torch.where(mask, idx, 0).reshape(-1)
        kg = k[:, :, idx_c, :].reshape(B, H, S, W, Dh)
        vg = v[:, :, idx_c, :].reshape(B, H, S, W, Dh)
        logits = torch.einsum("bhsd,bhswd->bhsw", q, kg) * scale
        logits = torch.where(mask[None, None, :, :], logits, -1e9)
        attn = _softmax(logits, axis=-1)
        o = torch.einsum("bhsw,bhswd->bhsd", attn, vg)
        return (lambda x, *d: x.permute(*d))(o, 0, 2, 1, 3).reshape(B, S, D) @ wo

    x = A_x
    g = _sigmoid((x * gate_w).sum(-1, keepdims=True))
    a = _A_ref(x, A_dft_seq_re, A_dft_seq_im, A_dft_hid_re, A_dft_hid_im)
    b = _B_ref(x, B_wqkv, B_wo)
    return g * a + (1 - g) * b
```

```asm
; @launch grid=(256,1,1) block=(512,1,1) lds=163840
.amdgcn_target "amdgcn-amd-amdhsa--gfx950"
.text
.p2alignl 12, 0xbf810000
.globl gated_mix__spectral_fnet__sliding_local_dilated__prompt_kernel
.p2align 8
.type gated_mix__spectral_fnet__sliding_local_dilated__prompt_kernel,@function
gated_mix__spectral_fnet__sliding_local_dilated__prompt_kernel:
    s_load_dwordx16 s[16:31], s[0:1], 0
    s_load_dwordx8 s[32:39], s[0:1], 64
    s_getpc_b64 s[64:65]
K_PC:
    v_lshrrev_b32 v15, 6, v0
    v_and_b32 v1, 63, v0
    s_cmp_ge_u32 s2, 256
    s_cbranch_scc1 K_END
    v_readfirstlane_b32 s3, v15
    s_and_b32 s4, s2, 7
    s_lshr_b32 s5, s2, 3
    v_lshrrev_b32 v16, 3, v1
    v_and_b32 v17, 7, v1
    v_lshlrev_b32 v19, 4, v1
    s_lshr_b32 s9, s5, 2
    s_and_b32 s11, s5, 3
    s_and_b32 s15, s3, 3
    s_cmp_lt_u32 s3, 4
    s_cbranch_scc1 K_COMP
    s_setprio 1
    s_lshl_b32 s6, s5, 2
    s_add_u32 s6, s6, s15
    s_mov_b32 s66, CODE_END-K_PC
    s_lshl_b32 s67, 1, 17
    v_lshrrev_b32 v2, 5, v1
    s_lshl_b32 s7, s6, 8
    v_lshlrev_b32 v2, 7, v2
    buffer_load_dword v15, v2, s[64:67], s7 offen
    s_lshr_b32 s8, s4, 1
    s_mul_i32 s8, s8, 6
    s_lshl_b32 s13, s8, 4
    s_add_u32 s13, s13, s6
    s_sub_u32 s13, s13, 32
    s_lshl_b32 s13, s13, 3
    s_and_b32 s10, s4, 1
    s_add_u32 s13, s13, s10
    s_lshl_b32 s13, s13, 9
    s_lshl_b32 s14, s4, 5
    s_add_u32 s14, s14, s6
    s_lshl_b32 s14, s14, 11
    s_lshr_b32 s12, s5, 3
    s_lshl_b32 s12, s12, 2
    s_add_u32 s92, s12, s15
    s_lshl_b32 s12, s92, 4
    s_add_u32 s12, s12, s4
    s_lshl_b32 s12, s12, 3
    s_and_b32 s7, s5, 7
    s_add_u32 s7, s7, s12
    s_lshl_b32 s7, s7, 10
    s_add_u32 s91, s7, 0x10000
    s_cmp_lt_u32 s5, 8
    s_cselect_b32 s93, s14, s13
    s_cselect_b32 s13, 9, 10
    v_lshrrev_b32 v3, 4, v1
    v_lshlrev_b32 v3, s13, v3
    v_bfe_u32 v4, v1, 2, 2
    v_lshl_add_u32 v20, v4, 7, v3
    v_lshrrev_b32 v18, 1, v16
    v_xor_b32 v18, v17, v18
    v_lshlrev_b32 v18, 4, v18
    s_lshl_b32 s42, 1, 21
    s_lshl_b32 s43, 1, 17
    s_lshl_b32 s47, 1, 17
    s_cmp_lt_u32 s5, 8
    s_cselect_b32 s76, 1, 3
    s_lshl_b32 s46, s76, 19
    s_waitcnt lgkmcnt(0)
    s_mov_b64 s[40:41], s[16:17]
    s_cmp_lt_u32 s5, 8
    buffer_load_dwordx4 v[240:243], v19, s[40:43], s7 offen
    buffer_load_dwordx4 v[244:247], v19, s[40:43], s91 offen
    s_cselect_b64 s[44:45], s[30:31], s[28:29]
    v_mov_b32 v8, v20
    s_cbranch_scc1 K_SLOAD
    s_sub_u32 s8, s8, 2
    s_add_u32 s8, s8, s9
    s_lshl_b32 s10, s10, 2
    s_add_u32 s10, s10, s11
    s_lshr_b32 s12, s8, 1
    s_mulk_i32 s12, 170
    s_and_b32 s13, s8, 1
    s_add_u32 s14, s12, s13
    s_mul_i32 s76, s15, 48
    s_add_u32 s14, s14, s76
    s_lshl_b32 s14, s14, 10
    s_and_b32 s78, s15, 1
    s_lshl_b32 s78, s78, 6
    v_xor_b32 v2, s78, v18
    v_lshl_add_u32 v2, v16, 11, v2
    v_add_u32 v2, s14, v2
    s_movk_i32 s77, 15360
    v_xad_u32 v3, v2, 64, s77
    s_movk_i32 s77, 30720
    v_add_u32 v4, s77, v2
    s_lshl_b32 s76, s76, 3
    s_add_u32 s76, s76, s10
    s_lshl_b32 s76, s76, 7
    s_movk_i32 s77, 3072
    v_and_b32 v5, 2, v16
    v_xor_b32 v5, v5, v17
    v_lshlrev_b32 v5, 4, v5
    v_mad_u32_u24 v5, v16, s77, v5
    v_add_u32 v5, s76, v5
    s_movk_i32 s77, 23552
    v_xad_u32 v6, v5, 64, s77
    s_mov_b32 s76, 0
    s_mul_i32 s78, s15, 3072
    s_add_u32 s81, s78, 49152
    s_addk_i32 s78, 12288
    s_lshl_b32 s79, s15, 11
    s_add_u32 s79, s79, 73728
    s_mov_b32 s80, 0
    s_movk_i32 s82, 8192
    v_mov_b32 v7, 0
    s_mov_b64 s[48:49], s[28:29]
    s_mov_b32 s50, 0
    s_lshl_b32 s51, 1, 17
    s_mov_b32 m0, s78
    s_mul_i32 s77, s76, 1536
    buffer_load_dwordx4 v2, s[40:43], s76 offen lds
    buffer_load_dwordx4 v3, s[40:43], s76 offen offset:1024 lds
    buffer_load_dwordx4 v4, s[40:43], s76 offen offset:2048 lds
    s_branch K_PRE2
K_QL:
    s_mov_b32 m0, s78
    s_mul_i32 s77, s76, 1536
    buffer_load_dwordx4 v2, s[40:43], s76 offen lds
    buffer_load_dwordx4 v3, s[40:43], s76 offen offset:1024 lds
    buffer_load_dwordx4 v4, s[40:43], s76 offen offset:2048 lds
K_QLB:
    s_mov_b32 m0, s79
    s_addk_i32 s76, 128
    buffer_load_dwordx4 v5, s[44:47], s77 offen lds
    buffer_load_dwordx4 v6, s[44:47], s77 offen offset:1024 lds
    s_add_u32 m0, m0, s82
    s_addk_i32 s77, 1024
    buffer_load_dwordx4 v5, s[44:47], s77 offen lds
    buffer_load_dwordx4 v6, s[44:47], s77 offen offset:1024 lds
    s_add_u32 m0, m0, s82
    s_addk_i32 s77, 1024
    buffer_load_dwordx4 v5, s[44:47], s77 offen lds
    buffer_load_dwordx4 v6, s[44:47], s77 offen offset:1024 lds
    s_addk_i32 s78, 12288
    s_addk_i32 s79, 24576
    s_cmp_eq_u32 s78, s81
    s_cselect_b32 s83, 49152, 0
    s_sub_u32 s78, s78, s83
    s_lshl_b32 s83, s83, 1
    s_sub_u32 s79, s79, s83
    s_add_u32 s80, s80, 1
    s_cmp_le_u32 s80, 1
    s_cbranch_scc1 K_QL
    s_waitcnt vmcnt(9)
    s_barrier
    s_cmp_lt_u32 s80, 8
    s_cbranch_scc1 K_QL
    s_branch K_P2L
K_SLOAD:
    buffer_load_dword v15, v20, s[44:47], s93 offen
    s_lshl_b32 s8, s4, 1
    s_add_u32 s8, s8, s9
    s_lshl_b32 s10, s11, 5
    s_lshl_b32 s77, s15, 3
    s_add_u32 s10, s10, s77
    s_mov_b32 s76, 0
    s_lshl_b32 s77, s8, 2
    s_add_u32 s77, s77, s15
    s_lshl_b32 s77, s77, 10
    v_lshl_add_u32 v2, v16, 16, v18
    v_add_u32 v2, s77, v2
    s_mov_b32 s77, 523264
    v_xad_u32 v3, v2, 64, s77
    s_lshl_b32 s77, s77, 1
    v_add_u32 v4, s77, v2
    v_add_u32 v5, s77, v3
    s_add_u32 s78, s15, 4
    s_lshl_b32 s78, s78, 12
    s_mov_b32 s80, 0
    s_lshl_b32 s81, 1, 16
    s_lshl_b32 s78, s15, 12
    s_mov_b64 s[48:49], s[28:29]
    s_and_b32 s77, s4, 1
    s_cselect_b32 s77, 0, 3
    s_lshl_b32 s50, s77, 19
    s_lshl_b32 s51, 1, 17
    v_lshrrev_b32 v7, 2, v1
    v_min_u32 v7, 5, v7
    s_mul_i32 s77, s6, 6
    v_add_lshl_u32 v7, v7, s77, 10
    v_mov_b32 v6, 0
    s_mov_b32 m0, s78
    s_addk_i32 s78, 16384
    buffer_load_dwordx4 v2, s[40:43], s76 offen lds
    buffer_load_dwordx4 v3, s[40:43], s76 offen offset:1024 lds
    buffer_load_dwordx4 v4, s[40:43], s76 offen offset:2048 lds
    buffer_load_dwordx4 v5, s[40:43], s76 offen offset:3072 lds
    s_branch K_PRE2
K_SL:
    s_mov_b32 m0, s78
    s_addk_i32 s78, 16384
    buffer_load_dwordx4 v2, s[40:43], s76 offen lds
    buffer_load_dwordx4 v3, s[40:43], s76 offen offset:1024 lds
    buffer_load_dwordx4 v4, s[40:43], s76 offen offset:2048 lds
    buffer_load_dwordx4 v5, s[40:43], s76 offen offset:3072 lds
K_SLB:
    s_mul_i32 s77, s76, 1536
    buffer_load_dword v15, v7, s[48:51], s77 offen offset:384
    s_cmp_lg_u32 s80, 3
    s_cbranch_scc1 K_SLT
    buffer_load_dwordx4 v[248:251], v19, s[56:59], 0 offen
K_SLT:
    s_addk_i32 s76, 128
    s_add_u32 s80, s80, 1
    s_cmp_le_u32 s80, 2
    s_cbranch_scc1 K_SL
    s_waitcnt vmcnt(11)
    s_barrier
    s_cmp_lt_u32 s80, 8
    s_cbranch_scc1 K_SL
    v_mov_b32 v252, 0
    v_mov_b32 v253, 0
    v_dot2c_f32_bf16 v252, v240, v248
    v_dot2c_f32_bf16 v253, v244, v248
    v_dot2c_f32_bf16 v252, v241, v249
    v_dot2c_f32_bf16 v253, v245, v249
    v_dot2c_f32_bf16 v252, v242, v250
    v_dot2c_f32_bf16 v253, v246, v250
    v_dot2c_f32_bf16 v252, v243, v251
    v_dot2c_f32_bf16 v253, v247, v251
    s_cmp_lt_u32 s5, 8
    s_cselect_b32 s90, 1, 6
    s_lshl_b32 s90, s90, 9
    s_add_u32 s90, s90, s15
    s_lshl_b32 s90, s90, 3
    v_mov_b32 v244, s90
    v_add_f32_dpp v252, v252, v252 row_shr:1 row_mask:0xf bank_mask:0xf bound_ctrl:1
    v_add_f32_dpp v253, v253, v253 row_shr:1 row_mask:0xf bank_mask:0xf bound_ctrl:1
    s_nop 0
    v_add_f32_dpp v252, v252, v252 row_shr:2 row_mask:0xf bank_mask:0xf bound_ctrl:1
    v_add_f32_dpp v253, v253, v253 row_shr:2 row_mask:0xf bank_mask:0xf bound_ctrl:1
    s_nop 0
    v_add_f32_dpp v252, v252, v252 row_shr:4 row_mask:0xf bank_mask:0xf bound_ctrl:1
    v_add_f32_dpp v253, v253, v253 row_shr:4 row_mask:0xf bank_mask:0xf bound_ctrl:1
    s_nop 0
    v_add_f32_dpp v252, v252, v252 row_shr:8 row_mask:0xf bank_mask:0xf bound_ctrl:1
    v_add_f32_dpp v253, v253, v253 row_shr:8 row_mask:0xf bank_mask:0xf bound_ctrl:1
    s_nop 0
    v_add_f32_dpp v252, v252, v252 row_bcast:15 row_mask:0xa bank_mask:0xf
    v_add_f32_dpp v253, v253, v253 row_bcast:15 row_mask:0xa bank_mask:0xf
    s_nop 0
    v_add_f32_dpp v252, v252, v252 row_bcast:31 row_mask:0xc bank_mask:0xf
    v_add_f32_dpp v253, v253, v253 row_bcast:31 row_mask:0xc bank_mask:0xf
    v_mul_f32 v252, 0xbfb8aa3b, v252
    v_mul_f32 v253, 0xbfb8aa3b, v253
    v_exp_f32 v252, v252
    v_exp_f32 v253, v253
    v_add_f32 v252, 1.0, v252
    v_add_f32 v253, 1.0, v253
    v_rcp_f32 v252, v252
    v_rcp_f32 v253, v253
    s_mov_b32 exec_lo, 0
    s_brev_b32 exec_hi, 1
    ds_write_b64 v244, v[252:253]
    s_mov_b64 exec, -1
    s_waitcnt lgkmcnt(0)
    s_waitcnt vmcnt(6)
    s_barrier
    s_branch K_P2L
K_PRE2:
    s_and_b32 s6, s5, 7
    s_lshr_b32 s7, s5, 3
    s_lshl_b32 s8, s4, 1
    s_lshr_b32 s9, s7, 1
    s_add_u32 s8, s8, s9
    s_sub_u32 s9, 32, s8
    s_cmp_eq_u32 s8, 0
    s_cselect_b32 s9, 16, s9
    s_bitcmp1_b32 s7, 0
    s_cselect_b32 s8, s9, s8
    v_mov_b32 v20, 1
    v_and_b32 v21, 7, v1
    v_lshlrev_b32 v21, 2, v21
    v_and_b32 v35, 2, v16
    v_lshlrev_b32 v35, 1, v35
    v_xor_b32 v35, v35, v17
    v_lshlrev_b32 v35, 4, v35
    v_lshl_add_u32 v35, v16, 10, v35
    s_lshl_b32 s88, s15, 14
    s_lshl_b32 s89, s6, 7
    s_add_u32 s88, s88, s89
    v_add_u32 v35, s88, v35
    v_add_u32 v36, 7168, v35
    s_lshl_b32 s74, s15, 11
    s_sub_u32 s9, 32, s8
    s_and_b32 s9, s9, 31
    s_cmp_ge_u32 s6, 4
    s_cselect_b32 s9, s9, s8
    s_cselect_b32 s10, -16, 16
    s_lshl_b32 s11, s6, 10
    s_sub_u32 s12, 8192, s11
    s_cmp_ge_u32 s6, 4
    s_cselect_b32 s11, s12, s11
    s_mul_i32 s14, s9, 67584
    s_add_u32 s14, s14, s11
    s_mul_i32 s88, s15, 16896
    s_add_u32 s14, s14, s88
    s_add_u32 s14, s14, 2162688
    v_mul_i32_i24 v32, s10, v1
    v_add_u32 v32, s11, v32
    s_sub_u32 s14, s14, s11
    s_movk_i32 s89, 2048
    v_subrev_u32 v26, 16, v32
    v_cmp_lt_u32 vcc, s89, v32
    v_cmp_eq_u32 s[90:91], s89, v32
    s_lshl_b32 s88, s15, 7
    s_add_u32 s88, s88, s9
    s_lshl_b32 s88, s88, 4
    s_add_u32 s88, s88, 4390912
    v_mov_b32 v27, s88
    v_cndmask_b32 v32, v32, v26, vcc
    v_add_u32 v32, s14, v32
    v_cndmask_b32 v32, v32, v27, s[90:91]
    v_mov_b32 v27, -3712
    v_cndmask_b32_e64 v27, 0, v27, s[90:91]
    v_add_u32 v37, v32, v27
    v_add_u32 v38, v37, v27
    v_add_u32 v39, v38, v27
    s_lshl_b32 s88, s15, 15
    s_and_b32 s89, s8, 1
    s_lshl_b32 s89, s89, 17
    s_add_u32 s88, s88, s89
    s_lshr_b32 s89, s8, 1
    s_lshl_b32 s89, s89, 7
    s_add_u32 s88, s88, s89
    v_lshl_add_u32 v33, v16, 11, v18
    v_add_u32 v33, s88, v33
    s_movk_i32 s89, 15360
    v_xad_u32 v34, v33, 64, s89
    v_lshlrev_b32 v23, 8, v1
    v_lshlrev_b32 v24, 13, v1
    v_mov_b32 v22, 1
    v_mov_b32 v25, 8
    s_lshl_b32 s75, s15, 12
    s_lshl_b32 s72, s4, 13
    s_add_u32 s72, s72, 4521984
    s_lshl_b32 s73, s5, 8
    s_add_u32 s73, s73, 4521984
    s_movk_i32 s84, 20000
    s_mov_b64 s[56:57], s[32:33]
    s_lshl_b32 s58, 1, 10
    s_lshl_b32 s59, 1, 17
    s_cmp_lt_u32 s5, 8
    s_cbranch_scc1 K_SLB
    buffer_load_dword v15, v8, s[44:47], s93 offen
    s_branch K_QLB
K_P2L:
    s_mov_b64 s[56:57], s[32:33]
    s_lshl_b32 s58, 1, 10
    s_lshl_b32 s59, 1, 17
    s_mov_b64 s[68:69], s[30:31]
    s_lshl_b32 s70, 1, 19
    s_lshl_b32 s71, 1, 17
    s_mov_b64 s[64:65], s[36:37]
    s_lshl_b32 s66, 1, 8
    s_lshl_b32 s67, 1, 17
    s_mov_b64 s[60:61], s[38:39]
    s_mov_b32 s62, 4980736
    s_mov_b32 s63, 0x20000
    buffer_load_dwordx4 v[248:251], v19, s[56:59], 0 offen
    s_waitcnt vmcnt(2)
    s_cmp_lt_u32 s5, 8
    s_cbranch_scc1 K_X7
    s_waitcnt vmcnt(1)
K_X7:
    s_barrier
    s_cmp_lt_u32 s5, 8
    s_cbranch_scc0 K_WO
    s_waitcnt vmcnt(0)
    s_branch K_WOB
K_WO:
    s_add_u32 m0, s74, 81920
    s_mov_b32 s76, 0
    buffer_load_dwordx4 v35, s[68:71], s76 offen lds
    buffer_load_dwordx4 v36, s[68:71], s76 offen offset:1024 lds
    s_add_u32 m0, s74, 90112
    s_mov_b32 s76, 65536
    buffer_load_dwordx4 v35, s[68:71], s76 offen lds
    buffer_load_dwordx4 v36, s[68:71], s76 offen offset:1024 lds
    s_add_u32 m0, s74, 98304
    s_mov_b32 s76, 131072
    buffer_load_dwordx4 v35, s[68:71], s76 offen lds
    buffer_load_dwordx4 v36, s[68:71], s76 offen offset:1024 lds
    s_add_u32 m0, s74, 106496
    s_mov_b32 s76, 196608
    buffer_load_dwordx4 v35, s[68:71], s76 offen lds
    buffer_load_dwordx4 v36, s[68:71], s76 offen offset:1024 lds
    s_add_u32 m0, s74, 114688
    s_mov_b32 s76, 262144
    buffer_load_dwordx4 v35, s[68:71], s76 offen lds
    buffer_load_dwordx4 v36, s[68:71], s76 offen offset:1024 lds
    s_add_u32 m0, s74, 122880
    s_mov_b32 s76, 327680
    buffer_load_dwordx4 v35, s[68:71], s76 offen lds
    buffer_load_dwordx4 v36, s[68:71], s76 offen offset:1024 lds
    s_add_u32 m0, s74, 131072
    s_mov_b32 s76, 393216
    buffer_load_dwordx4 v35, s[68:71], s76 offen lds
    buffer_load_dwordx4 v36, s[68:71], s76 offen offset:1024 lds
    s_add_u32 m0, s74, 139264
    s_mov_b32 s76, 458752
    buffer_load_dwordx4 v35, s[68:71], s76 offen lds
    buffer_load_dwordx4 v36, s[68:71], s76 offen offset:1024 lds
    s_cmp_lt_u32 s5, 8
    s_cbranch_scc1 K_WOC
    s_waitcnt vmcnt(16)
K_WOB:
    s_cmp_lg_u32 s15, 0
    s_cbranch_scc1 K_NOGO
    buffer_load_dword v20, v21, s[64:67], 0 offen sc1
K_NOGO:
    s_cmp_lt_u32 s5, 8
    s_cbranch_scc1 K_GST
    v_mov_b32 v252, 0
    v_mov_b32 v253, 0
    v_dot2c_f32_bf16 v252, v240, v248
    v_dot2c_f32_bf16 v253, v244, v248
    v_dot2c_f32_bf16 v252, v241, v249
    v_dot2c_f32_bf16 v253, v245, v249
    v_dot2c_f32_bf16 v252, v242, v250
    v_dot2c_f32_bf16 v253, v246, v250
    v_dot2c_f32_bf16 v252, v243, v251
    v_dot2c_f32_bf16 v253, v247, v251
    s_cmp_lt_u32 s5, 8
    s_cselect_b32 s90, 1, 6
    s_lshl_b32 s90, s90, 9
    s_add_u32 s90, s90, s15
    s_lshl_b32 s90, s90, 3
    v_mov_b32 v244, s90
    v_add_f32_dpp v252, v252, v252 row_shr:1 row_mask:0xf bank_mask:0xf bound_ctrl:1
    v_add_f32_dpp v253, v253, v253 row_shr:1 row_mask:0xf bank_mask:0xf bound_ctrl:1
    s_nop 0
    v_add_f32_dpp v252, v252, v252 row_shr:2 row_mask:0xf bank_mask:0xf bound_ctrl:1
    v_add_f32_dpp v253, v253, v253 row_shr:2 row_mask:0xf bank_mask:0xf bound_ctrl:1
    s_nop 0
    v_add_f32_dpp v252, v252, v252 row_shr:4 row_mask:0xf bank_mask:0xf bound_ctrl:1
    v_add_f32_dpp v253, v253, v253 row_shr:4 row_mask:0xf bank_mask:0xf bound_ctrl:1
    s_nop 0
    v_add_f32_dpp v252, v252, v252 row_shr:8 row_mask:0xf bank_mask:0xf bound_ctrl:1
    v_add_f32_dpp v253, v253, v253 row_shr:8 row_mask:0xf bank_mask:0xf bound_ctrl:1
    s_nop 0
    v_add_f32_dpp v252, v252, v252 row_bcast:15 row_mask:0xa bank_mask:0xf
    v_add_f32_dpp v253, v253, v253 row_bcast:15 row_mask:0xa bank_mask:0xf
    s_nop 0
    v_add_f32_dpp v252, v252, v252 row_bcast:31 row_mask:0xc bank_mask:0xf
    v_add_f32_dpp v253, v253, v253 row_bcast:31 row_mask:0xc bank_mask:0xf
    v_mul_f32 v252, 0xbfb8aa3b, v252
    v_mul_f32 v253, 0xbfb8aa3b, v253
    v_exp_f32 v252, v252
    v_exp_f32 v253, v253
    v_add_f32 v252, 1.0, v252
    v_add_f32 v253, 1.0, v253
    v_rcp_f32 v252, v252
    v_rcp_f32 v253, v253
    s_mov_b32 exec_lo, 0
    s_brev_b32 exec_hi, 1
    ds_write_b64 v244, v[252:253]
    s_mov_b64 exec, -1
    s_waitcnt lgkmcnt(0)
K_GST:
    s_cmp_lt_u32 s5, 8
    s_cbranch_scc1 K_NOSTG
    s_barrier
K_NOSTG:
    s_cmp_lg_u32 s15, 2
    s_cbranch_scc1 K_NOGS
    v_and_b32 v245, 16, v19
    s_sub_u32 s90, s90, 16
    v_add_u32 v245, s90, v245
    ds_read_b128 v[248:251], v245
    s_and_b32 s90, s4, 3
    s_lshl_b32 s90, s90, 3
    s_and_b32 s91, s5, 7
    s_add_u32 s90, s90, s91
    s_lshl_b32 s90, s90, 1
    s_lshr_b32 s91, s4, 2
    s_add_u32 s90, s90, s91
    s_lshl_b32 s90, s90, 2
    s_lshr_b32 s91, s5, 3
    s_add_u32 s90, s90, s91
    s_lshl_b32 s90, s90, 7
    s_add_u32 s90, s90, 4456448
    s_mov_b64 exec, 0xff
    s_waitcnt lgkmcnt(0)
    buffer_store_dwordx4 v[248:251], v19, s[60:63], s90 offen sc1
    s_mov_b64 exec, -1
K_NOGS:
    s_waitcnt vmcnt(0)
K_GO:
    v_cmp_eq_u32 vcc, 1, v20
    s_sub_u32 s84, s84, 1
    s_cbranch_scc1 K_GOK
    s_cmp_eq_u64 vcc, -1
    s_cbranch_scc1 K_GOK
    buffer_load_dword v20, v21, s[64:67], 0 offen sc1
    s_waitcnt vmcnt(0)
    s_branch K_GO
K_GOK:
    s_mov_b32 s89, s15
    s_cmp_lt_u32 s5, 8
    s_cselect_b32 s85, 1, s15
    s_cmp_lg_u32 s85, 0
    s_cbranch_scc1 K_PREX
    s_mov_b64 exec, 0xff
    buffer_load_dword v26, v23, s[60:63], s72 offen sc1
    s_waitcnt vmcnt(0)
    v_cmp_eq_u32 vcc, v25, v26
    s_cmp_eq_u64 vcc, exec
    s_cbranch_scc1 K_PREY
    buffer_load_dword v26, v23, s[60:63], s72 offen sc1
    s_waitcnt vmcnt(0)
    v_cmp_eq_u32 vcc, v25, v26
    s_cmp_eq_u64 vcc, exec
K_PREY:
    s_cselect_b32 s89, 1, 0
    s_mov_b64 exec, -1
K_PREX:
    s_barrier
    s_cmp_lg_u32 s15, 1
    s_cbranch_scc1 K_NOSIG
    s_mov_b64 exec, 0xff
    buffer_atomic_add v22, v24, s[60:63], s73 offen sc1
    s_mov_b64 exec, -1
K_NOSIG:
    s_cmp_lt_u32 s5, 8
    s_cbranch_scc1 K_WO
K_WOC:
    s_cmp_lg_u32 s89, 0
    s_cbranch_scc1 K_POLLSX
    s_mov_b32 exec_lo, 0xff
    s_mov_b32 exec_hi, 0
    s_movk_i32 s84, 30000
K_POLLS:
    buffer_load_dword v26, v23, s[60:63], s72 offen sc1
    s_sub_u32 s84, s84, 1
    s_cbranch_scc1 K_POLLSY
    s_waitcnt vmcnt(0)
    v_cmp_eq_u32 vcc, v25, v26
    s_andn2_b64 exec, exec, vcc
    s_cbranch_scc0 K_POLLSY
    s_branch K_POLLS
K_POLLSY:
    s_mov_b64 exec, -1
K_POLLSX:
    s_barrier
    s_add_u32 m0, s75, 147456
    s_mov_b32 s76, 0
    buffer_load_dwordx4 v32, s[60:63], s76 offen sc1 lds
    s_movk_i32 s76, 3200
    buffer_load_dwordx4 v37, s[60:63], s76 offen offset:1024 sc1 lds
    s_movk_i32 s76, 6400
    buffer_load_dwordx4 v38, s[60:63], s76 offen offset:2048 sc1 lds
    s_movk_i32 s76, 9600
    buffer_load_dwordx4 v39, s[60:63], s76 offen offset:3072 sc1 lds
    s_waitcnt vmcnt(0)
    s_barrier
    s_cmp_lg_u32 s15, 0
    s_cbranch_scc1 K_POLLX
    s_mov_b32 exec_lo, 0xffffff00
    s_mov_b32 exec_hi, 0
    s_movk_i32 s84, 30000
K_POLL:
    buffer_load_dword v26, v23, s[60:63], s72 offen sc1
    s_sub_u32 s84, s84, 1
    s_cbranch_scc1 K_POLLY
    s_waitcnt vmcnt(0)
    v_cmp_eq_u32 vcc, v25, v26
    s_andn2_b64 exec, exec, vcc
    s_cbranch_scc0 K_POLLY
    s_branch K_POLL
K_POLLY:
    s_mov_b64 exec, -1
K_POLLX:
    s_barrier
    s_add_u32 m0, s74, 0
    s_mov_b32 s76, 0
    buffer_load_dwordx4 v33, s[60:63], s76 offen sc1 lds
    buffer_load_dwordx4 v34, s[60:63], s76 offen offset:1024 sc1 lds
    s_add_u32 m0, s74, 8192
    s_mov_b32 s76, 262272
    buffer_load_dwordx4 v33, s[60:63], s76 offen sc1 lds
    buffer_load_dwordx4 v34, s[60:63], s76 offen offset:1024 sc1 lds
    s_add_u32 m0, s74, 16384
    s_mov_b32 s76, 524544
    buffer_load_dwordx4 v33, s[60:63], s76 offen sc1 lds
    buffer_load_dwordx4 v34, s[60:63], s76 offen offset:1024 sc1 lds
    s_add_u32 m0, s74, 24576
    s_mov_b32 s76, 786816
    buffer_load_dwordx4 v33, s[60:63], s76 offen sc1 lds
    buffer_load_dwordx4 v34, s[60:63], s76 offen offset:1024 sc1 lds
    s_add_u32 m0, s74, 32768
    s_mov_b32 s76, 1049088
    buffer_load_dwordx4 v33, s[60:63], s76 offen sc1 lds
    buffer_load_dwordx4 v34, s[60:63], s76 offen offset:1024 sc1 lds
    s_waitcnt vmcnt(8)
    s_barrier
    s_add_u32 m0, s74, 40960
    s_mov_b32 s76, 1311360
    buffer_load_dwordx4 v33, s[60:63], s76 offen sc1 lds
    buffer_load_dwordx4 v34, s[60:63], s76 offen offset:1024 sc1 lds
    s_waitcnt vmcnt(8)
    s_barrier
    s_add_u32 m0, s74, 49152
    s_mov_b32 s76, 1573632
    buffer_load_dwordx4 v33, s[60:63], s76 offen sc1 lds
    buffer_load_dwordx4 v34, s[60:63], s76 offen offset:1024 sc1 lds
    s_waitcnt vmcnt(8)
    s_barrier
    s_add_u32 m0, s74, 57344
    s_mov_b32 s76, 1835904
    buffer_load_dwordx4 v33, s[60:63], s76 offen sc1 lds
    buffer_load_dwordx4 v34, s[60:63], s76 offen offset:1024 sc1 lds
    s_waitcnt vmcnt(8)
    s_barrier
    s_waitcnt vmcnt(6)
    s_barrier
    s_waitcnt vmcnt(4)
    s_barrier
    s_waitcnt vmcnt(2)
    s_barrier
    s_waitcnt vmcnt(0)
    s_barrier
    s_endpgm
    .p2alignl 12, 0xbf810000
    .fill 100, 4, 0xbf810000
K_COMP:
    s_xor_b32 s91, s5, 1
    s_or_b32 s91, s91, s3
    s_cmp_lg_u32 s91, 0
    s_cbranch_scc1 K_NOZERO
    s_waitcnt lgkmcnt(0)
    s_mov_b64 s[60:61], s[38:39]
    s_mov_b32 s62, 4980736
    s_mov_b32 s63, 0x20000
    v_lshlrev_b32 v23, 8, v1
    v_mov_b32 v24, 0
    s_lshl_b32 s82, s4, 13
    s_add_u32 s82, s82, 4521984
    s_mov_b32 exec_hi, 0
    buffer_store_dword v24, v23, s[60:63], s82 offen sc1
    s_mov_b32 exec_hi, -1
K_NOZERO:
    v_and_b32 v20, 15, v1
    v_lshrrev_b32 v21, 4, v1
    v_lshrrev_b32 v11, 1, v20
    v_xor_b32 v11, v21, v11
    v_lshlrev_b32 v11, 4, v11
    v_lshl_or_b32 v11, v20, 7, v11
    v_xor_b32 v12, 64, v11
    v_mov_b32 v10, 0
    s_waitcnt lgkmcnt(0)
    s_mov_b64 s[60:61], s[38:39]
    s_mov_b32 s62, 4980736
    s_mov_b32 s63, 0x20000
    s_mov_b64 s[72:73], s[34:35]
    s_mov_b32 s74, 2097152
    s_mov_b32 s75, 0x20000
    s_cmp_lt_u32 s5, 8
    s_cbranch_scc0 K_QKV
K_SPEC:
    s_lshl_b32 s8, s4, 1
    s_add_u32 s8, s8, s9
    s_lshl_b32 s10, s11, 5
    s_lshl_b32 s77, s15, 3
    s_add_u32 s10, s10, s77
    v_and_b32 v48, 7, v20
    v_lshrrev_b32 v51, 3, v20
    v_cvt_f32_u32 v50, v21
    v_add_u32 v48, s10, v48
    v_cvt_f32_u32 v51, v51
    v_mul_f32 v50, 0x41800000, v50
    v_cvt_f32_u32 v48, v48
    v_mul_f32 v51, 0xbe800000, v51
    v_and_b32 v80, 1, v20
    v_mul_f32 v48, 0xbb000000, v48
    v_mov_b32 v96, 0
    v_sub_u32 v80, 0, v80
    v_fma_f32 v50, v50, v48, v51
    v_mul_f32 v51, 0x42800000, v48
    v_cos_f32 v49, v48
    v_cos_f32 v216, v50
    v_add_f32 v217, v50, v48
    v_add_f32 v50, v50, v51
    v_add_f32 v49, v49, v49
    v_cos_f32 v217, v217
    v_add_f32 v233, v50, v48
    v_cos_f32 v232, v50
    v_cos_f32 v233, v233
    v_fma_f32 v218, v49, v217, -v216
    v_add_f32 v50, v50, v51
    v_mov_b32 v97, 0
    v_fma_f32 v219, v49, v218, -v217
    v_fma_f32 v234, v49, v233, -v232
    v_cvt_pk_bf16_f32 v184, v216, v218
    v_cvt_pk_bf16_f32 v188, v217, v219
    v_cos_f32 v216, v50
    v_fma_f32 v235, v49, v234, -v233
    v_add_f32 v217, v50, v48
    v_add_f32 v50, v50, v51
    v_cvt_pk_bf16_f32 v196, v233, v235
    v_cvt_pk_bf16_f32 v192, v232, v234
    v_add_f32 v233, v50, v48
    v_cos_f32 v217, v217
    v_cos_f32 v232, v50
    v_cos_f32 v233, v233
    v_fma_f32 v220, v49, v219, -v218
    v_fma_f32 v236, v49, v235, -v234
    v_fma_f32 v218, v49, v217, -v216
    v_fma_f32 v221, v49, v220, -v219
    v_fma_f32 v237, v49, v236, -v235
    v_fma_f32 v234, v49, v233, -v232
    v_fma_f32 v222, v49, v221, -v220
    v_fma_f32 v238, v49, v237, -v236
    v_fma_f32 v219, v49, v218, -v217
    v_fma_f32 v235, v49, v234, -v233
    v_fma_f32 v223, v49, v222, -v221
    v_cvt_pk_bf16_f32 v185, v220, v222
    v_fma_f32 v239, v49, v238, -v237
    v_cvt_pk_bf16_f32 v193, v236, v238
    v_fma_f32 v220, v49, v219, -v218
    v_fma_f32 v236, v49, v235, -v234
    v_fma_f32 v224, v49, v223, -v222
    v_cvt_pk_bf16_f32 v189, v221, v223
    v_fma_f32 v240, v49, v239, -v238
    v_cvt_pk_bf16_f32 v197, v237, v239
    v_fma_f32 v221, v49, v220, -v219
    v_fma_f32 v237, v49, v236, -v235
    v_fma_f32 v225, v49, v224, -v223
    v_fma_f32 v241, v49, v240, -v239
    v_fma_f32 v222, v49, v221, -v220
    v_fma_f32 v238, v49, v237, -v236
    v_fma_f32 v226, v49, v225, -v224
    v_fma_f32 v242, v49, v241, -v240
    v_fma_f32 v223, v49, v222, -v221
    v_fma_f32 v239, v49, v238, -v237
    v_fma_f32 v227, v49, v226, -v225
    v_cvt_pk_bf16_f32 v186, v224, v226
    v_fma_f32 v243, v49, v242, -v241
    v_cvt_pk_bf16_f32 v194, v240, v242
    v_fma_f32 v224, v49, v223, -v222
    v_fma_f32 v240, v49, v239, -v238
    v_fma_f32 v228, v49, v227, -v226
    v_cvt_pk_bf16_f32 v190, v225, v227
    v_fma_f32 v244, v49, v243, -v242
    v_cvt_pk_bf16_f32 v198, v241, v243
    v_fma_f32 v225, v49, v224, -v223
    v_fma_f32 v241, v49, v240, -v239
    v_fma_f32 v229, v49, v228, -v227
    v_fma_f32 v245, v49, v244, -v243
    v_fma_f32 v226, v49, v225, -v224
    v_fma_f32 v242, v49, v241, -v240
    v_fma_f32 v230, v49, v229, -v228
    v_fma_f32 v246, v49, v245, -v244
    v_fma_f32 v227, v49, v226, -v225
    v_fma_f32 v243, v49, v242, -v241
    v_fma_f32 v231, v49, v230, -v229
    v_cvt_pk_bf16_f32 v187, v228, v230
    v_fma_f32 v247, v49, v246, -v245
    v_cvt_pk_bf16_f32 v195, v244, v246
    v_fma_f32 v228, v49, v227, -v226
    v_fma_f32 v244, v49, v243, -v242
    v_cvt_pk_bf16_f32 v191, v229, v231
    v_cvt_pk_bf16_f32 v199, v245, v247
    v_fma_f32 v229, v49, v228, -v227
    v_fma_f32 v245, v49, v244, -v243
    v_add_u32 v13, 0x10000, v11
    v_fma_f32 v230, v49, v229, -v228
    v_fma_f32 v246, v49, v245, -v244
    v_add_u32 v14, 0x10000, v12
    v_fma_f32 v231, v49, v230, -v229
    v_fma_f32 v247, v49, v246, -v245
    v_and_b32 v80, 0x80008000, v80
    v_mov_b32 v82, 0xdddd8888
    v_cvt_pk_bf16_f32 v200, v216, v218
    v_cvt_pk_bf16_f32 v204, v217, v219
    v_cvt_pk_bf16_f32 v201, v220, v222
    v_cvt_pk_bf16_f32 v205, v221, v223
    v_cvt_pk_bf16_f32 v202, v224, v226
    v_cvt_pk_bf16_f32 v206, v225, v227
    v_cvt_pk_bf16_f32 v203, v228, v230
    v_cvt_pk_bf16_f32 v207, v229, v231
    v_cvt_pk_bf16_f32 v208, v232, v234
    v_cvt_pk_bf16_f32 v212, v233, v235
    v_cvt_pk_bf16_f32 v209, v236, v238
    v_cvt_pk_bf16_f32 v213, v237, v239
    v_cvt_pk_bf16_f32 v210, v240, v242
    v_cvt_pk_bf16_f32 v214, v241, v243
    v_cvt_pk_bf16_f32 v211, v244, v246
    v_cvt_pk_bf16_f32 v215, v245, v247
    v_pk_mov_b32 v[98:99], v[96:97], v[96:97]
    v_pk_mov_b32 v[100:101], v[96:97], v[96:97]
    v_pk_mov_b32 v[102:103], v[96:97], v[96:97]
    v_pk_mov_b32 v[104:105], v[96:97], v[96:97]
    v_pk_mov_b32 v[106:107], v[96:97], v[96:97]
    v_pk_mov_b32 v[108:109], v[96:97], v[96:97]
    v_pk_mov_b32 v[110:111], v[96:97], v[96:97]
    v_pk_mov_b32 v[112:113], v[96:97], v[96:97]
    v_pk_mov_b32 v[114:115], v[96:97], v[96:97]
    v_pk_mov_b32 v[116:117], v[96:97], v[96:97]
    v_pk_mov_b32 v[118:119], v[96:97], v[96:97]
    v_pk_mov_b32 v[120:121], v[96:97], v[96:97]
    v_pk_mov_b32 v[122:123], v[96:97], v[96:97]
    v_pk_mov_b32 v[124:125], v[96:97], v[96:97]
    v_pk_mov_b32 v[126:127], v[96:97], v[96:97]
    v_pk_mov_b32 v[128:129], v[96:97], v[96:97]
    v_pk_mov_b32 v[130:131], v[96:97], v[96:97]
    v_pk_mov_b32 v[132:133], v[96:97], v[96:97]
    v_pk_mov_b32 v[134:135], v[96:97], v[96:97]
    v_pk_mov_b32 v[136:137], v[96:97], v[96:97]
    v_pk_mov_b32 v[138:139], v[96:97], v[96:97]
    v_pk_mov_b32 v[140:141], v[96:97], v[96:97]
    v_pk_mov_b32 v[142:143], v[96:97], v[96:97]
    v_pk_mov_b32 v[144:145], v[96:97], v[96:97]
    v_pk_mov_b32 v[146:147], v[96:97], v[96:97]
    v_pk_mov_b32 v[148:149], v[96:97], v[96:97]
    v_pk_mov_b32 v[150:151], v[96:97], v[96:97]
    v_pk_mov_b32 v[152:153], v[96:97], v[96:97]
    v_pk_mov_b32 v[154:155], v[96:97], v[96:97]
    v_pk_mov_b32 v[156:157], v[96:97], v[96:97]
    v_pk_mov_b32 v[158:159], v[96:97], v[96:97]
    v_mov_b32 v94, -1
    s_cmp_lg_u32 s10, 0
    s_cbranch_scc1 K_NOPRE
    v_mov_b32 v22, 0xbf803f80
    v_mov_b32 v23, 0x3f80bf80
    s_mov_b32 exec_lo, 0x01000100
    s_mov_b32 exec_hi, 0x01000100
    v_mov_b32 v184, v22
    v_mov_b32 v188, v23
    v_mov_b32 v185, v22
    v_mov_b32 v189, v23
    v_mov_b32 v186, v22
    v_mov_b32 v190, v23
    v_mov_b32 v187, v22
    v_mov_b32 v191, v23
    v_mov_b32 v192, v22
    v_mov_b32 v196, v23
    v_mov_b32 v193, v22
    v_mov_b32 v197, v23
    v_mov_b32 v194, v22
    v_mov_b32 v198, v23
    v_mov_b32 v195, v22
    v_mov_b32 v199, v23
    v_mov_b32 v200, v22
    v_mov_b32 v204, v23
    v_mov_b32 v201, v22
    v_mov_b32 v205, v23
    v_mov_b32 v202, v22
    v_mov_b32 v206, v23
    v_mov_b32 v203, v22
    v_mov_b32 v207, v23
    v_mov_b32 v208, v22
    v_mov_b32 v212, v23
    v_mov_b32 v209, v22
    v_mov_b32 v213, v23
    v_mov_b32 v210, v22
    v_mov_b32 v214, v23
    v_mov_b32 v211, v22
    v_mov_b32 v215, v23
    s_mov_b32 exec_lo, 0
    s_mov_b32 exec_hi, 0xffff
    v_mov_b32 v94, 0xffff0000
    s_mov_b64 exec, -1
K_NOPRE:
    v_cvt_f32_u32 v22, v20
    v_cvt_f32_u32 v23, v21
    v_mul_f32 v24, 0x3d000000, v22
    v_mul_f32 v23, 4.0, v23
    v_mul_f32 v26, v24, v23
    v_add_f32 v27, v24, v26
    v_fma_f32 v28, v24, 2.0, v26
    v_sin_f32 v30, v26
    v_fma_f32 v29, v24, 2.0, v27
    v_sin_f32 v31, v27
    v_sin_f32 v32, v28
    v_sin_f32 v33, v29
    v_cos_f32 v26, v26
    v_cos_f32 v27, v27
    v_cos_f32 v28, v28
    v_cos_f32 v29, v29
    v_cvt_pk_bf16_f32 v160, v26, v27
    v_cvt_pk_bf16_f32 v168, v30, v31
    v_cvt_pk_bf16_f32 v169, v32, v33
    v_xor_b32 v162, v160, v80
    v_cvt_pk_bf16_f32 v161, v28, v29
    v_xor_b32 v164, 0x80000000, v160
    v_xor_b32 v166, 0x80000000, v162
    v_xor_b32 v163, v161, v80
    v_xor_b32 v165, 0x80000000, v161
    v_xor_b32 v170, v168, v80
    v_xor_b32 v167, 0x80000000, v163
    v_xor_b32 v171, v169, v80
    v_xor_b32 v172, 0x80000000, v168
    v_xor_b32 v173, 0x80000000, v169
    v_xor_b32 v174, 0x80000000, v170
    v_xor_b32 v175, 0x80000000, v171
    v_xor_b32 v176, 0x80008000, v160
    v_xor_b32 v177, 0x80008000, v161
    v_xor_b32 v178, 0x80008000, v162
    v_xor_b32 v179, 0x80008000, v163
    v_xor_b32 v180, 0x80008000, v164
    v_xor_b32 v181, 0x80008000, v165
    v_xor_b32 v182, 0x80008000, v166
    v_xor_b32 v183, 0x80008000, v167
    s_mul_i32 s76, s8, 4224
    s_add_u32 s76, s76, 2162688
    v_lshrrev_b32 v22, 1, v20
    v_and_b32 v22, 4, v22
    v_and_or_b32 v22, v20, 3, v22
    v_add_u32 v22, s10, v22
    v_sub_u32 v23, 255, v22
    v_and_b32 v24, 4, v20
    v_cmp_eq_u32 vcc, 0, v24
    v_mul_u32_u24 v252, 270336, v21
    s_nop 0
    v_cndmask_b32 v22, v23, v22, vcc
    v_lshl_add_u32 v252, v22, 4, v252
    v_add_u32 v252, s76, v252
    s_lshl_b32 s76, s8, 9
    s_add_u32 s76, s76, 4390912
    v_add_u32 v253, s76, v19
    s_lshl_b32 s76, s3, 13
    s_add_u32 s76, s76, 131072
    v_lshrrev_b32 v22, 2, v20
    v_xor_b32 v23, v21, v22
    v_and_b32 v23, 1, v23
    v_lshlrev_b32 v23, 4, v23
    v_lshl_or_b32 v23, v20, 5, v23
    v_lshrrev_b32 v24, 1, v21
    v_lshl_or_b32 v23, v24, 12, v23
    v_add_u32 v83, s76, v23
    v_sub_u32 v85, 0, v24
    v_and_b32 v85, 0x80008000, v85
    v_lshl_add_u32 v22, v21, 2, v22
    v_and_b32 v23, 1, v21
    v_lshlrev_b32 v23, 1, v23
    v_xor_b32 v23, v23, v20
    v_and_b32 v23, 3, v23
    v_lshlrev_b32 v23, 3, v23
    v_lshl_or_b32 v22, v22, 5, v23
    v_add_u32 v84, s76, v22
    s_and_b32 s6, s5, 7
    s_lshr_b32 s7, s5, 3
    s_lshl_b32 s8, s4, 1
    s_lshr_b32 s9, s7, 1
    s_add_u32 s8, s8, s9
    s_sub_u32 s9, 32, s8
    s_cmp_eq_u32 s8, 0
    s_cselect_b32 s9, 16, s9
    s_bitcmp1_b32 s7, 0
    s_cselect_b32 s8, s9, s8
    s_mov_b32 s88, 0x3a000000
    s_mov_b32 s89, 0xba000000
    s_cmp_ge_u32 s6, 4
    s_cselect_b32 s87, s88, s89
    s_lshr_b32 s78, s3, 1
    s_and_b32 s79, s3, 1
    v_and_b32 v22, 31, v1
    v_lshrrev_b32 v23, 5, v1
    s_lshl_b32 s76, s78, 5
    v_add_u32 v24, s76, v22
    v_lshlrev_b32 v25, 5, v24
    v_add_u32 v9, s8, v25
    s_lshl_b32 s76, s8, 8
    v_lshl_add_u32 v2, v24, 2, s76
    s_lshl_b32 s76, s8, 10
    v_and_b32 v26, 1, v24
    v_lshlrev_b32 v26, 9, v26
    v_lshrrev_b32 v27, 4, v24
    v_lshl_add_u32 v26, v27, 7, v26
    v_and_b32 v27, 14, v24
    v_lshl_add_u32 v26, v27, 1, v26
    v_add_u32 v2, s76, v26
    v_lshrrev_b32 v26, 2, v20
    v_lshl_add_u32 v26, v23, 3, v26
    v_lshlrev_b32 v26, 7, v26
    v_lshrrev_b32 v27, 3, v20
    v_xor_b32 v27, s79, v27
    v_lshl_add_u32 v26, v27, 6, v26
    v_and_b32 v27, 1, v21
    v_lshl_add_u32 v26, v27, 5, v26
    v_and_b32 v27, 3, v1
    v_lshl_add_u32 v26, v27, 3, v26
    v_add_u32 v8, 81920, v26
    v_bfe_u32 v26, v22, 1, 3
    v_xor_b32 v26, v26, v23
    v_lshlrev_b32 v26, 4, v26
    v_lshl_or_b32 v3, v24, 7, v26
    s_lshl_b32 s76, s79, 9
    s_add_u32 s76, s76, 147456
    v_lshlrev_b32 v26, 4, v22
    v_lshl_add_u32 v26, v23, 10, v26
    v_add_u32 v4, s76, v26
    s_lshl_b32 s76, s3, 11
    v_bfe_u32 v26, v22, 1, 2
    v_lshlrev_b32 v26, 4, v26
    v_lshl_or_b32 v26, v22, 6, v26
    v_lshl_or_b32 v26, v23, 3, v26
    v_add_u32 v5, s76, v26
    v_add_u32 v6, s76, v19
    v_lshrrev_b32 v27, 2, v1
    v_xor_b32 v26, v16, v1
    v_and_b32 v26, 3, v26
    v_lshlrev_b32 v26, 4, v26
    v_lshl_add_u32 v26, v27, 15, v26
    s_lshl_b32 s76, s78, 20
    s_lshl_b32 s77, s8, 10
    s_add_u32 s76, s76, s77
    s_lshl_b32 s77, s6, 1
    s_add_u32 s77, s77, s79
    s_lshl_b32 s77, s77, 6
    s_add_u32 s76, s76, s77
    v_add_u32 v7, s76, v26
    .p2align 3
    s_barrier
    s_nop 0
    ds_read_b128 v[16:19], v11 offset:0
    ds_read_b128 v[20:23], v12 offset:0
    ds_read_b128 v[24:27], v11 offset:2048
    ds_read_b128 v[28:31], v12 offset:2048
    ds_read_b128 v[32:35], v11 offset:4096
    ds_read_b128 v[36:39], v12 offset:4096
    ds_read_b128 v[40:43], v11 offset:6144
    ds_read_b128 v[44:47], v12 offset:6144
    s_waitcnt lgkmcnt(6)
    v_smfmac_f32_16x16x64_bf16 v[96:99], v[184:187], v[16:23], v82
    ds_read_b128 v[48:51], v11 offset:8192
    v_smfmac_f32_16x16x64_bf16 v[100:103], v[188:191], v[16:23], v82 abid:1
    ds_read_b128 v[52:55], v12 offset:8192
    s_waitcnt lgkmcnt(6)
    v_smfmac_f32_16x16x64_bf16 v[104:107], v[184:187], v[24:31], v82
    ds_read_b128 v[56:59], v11 offset:10240
    v_smfmac_f32_16x16x64_bf16 v[108:111], v[188:191], v[24:31], v82 abid:1
    ds_read_b128 v[60:63], v12 offset:10240
    s_waitcnt lgkmcnt(6)
    v_smfmac_f32_16x16x64_bf16 v[112:115], v[184:187], v[32:39], v82
    ds_read_b128 v[64:67], v11 offset:12288
    v_smfmac_f32_16x16x64_bf16 v[116:119], v[188:191], v[32:39], v82 abid:1
    ds_read_b128 v[68:71], v12 offset:12288
    s_waitcnt lgkmcnt(6)
    v_smfmac_f32_16x16x64_bf16 v[120:123], v[184:187], v[40:47], v82
    ds_read_b128 v[72:75], v11 offset:14336
    v_smfmac_f32_16x16x64_bf16 v[124:127], v[188:191], v[40:47], v82 abid:1
    ds_read_b128 v[76:79], v12 offset:14336
    s_waitcnt lgkmcnt(6)
    v_smfmac_f32_16x16x64_bf16 v[128:131], v[184:187], v[48:55], v82
    s_barrier
    ds_read_b128 v[16:19], v11 offset:16384
    v_smfmac_f32_16x16x64_bf16 v[132:135], v[188:191], v[48:55], v82 abid:1
    ds_read_b128 v[20:23], v12 offset:16384
    s_waitcnt lgkmcnt(6)
    v_smfmac_f32_16x16x64_bf16 v[136:139], v[184:187], v[56:63], v82
    ds_read_b128 v[24:27], v11 offset:18432
    v_smfmac_f32_16x16x64_bf16 v[140:143], v[188:191], v[56:63], v82 abid:1
    ds_read_b128 v[28:31], v12 offset:18432
    s_waitcnt lgkmcnt(6)
    v_smfmac_f32_16x16x64_bf16 v[144:147], v[184:187], v[64:71], v82
    ds_read_b128 v[32:35], v11 offset:20480
    v_smfmac_f32_16x16x64_bf16 v[148:151], v[188:191], v[64:71], v82 abid:1
    ds_read_b128 v[36:39], v12 offset:20480
    s_waitcnt lgkmcnt(6)
    v_smfmac_f32_16x16x64_bf16 v[152:155], v[184:187], v[72:79], v82
    ds_read_b128 v[40:43], v11 offset:22528
    v_smfmac_f32_16x16x64_bf16 v[156:159], v[188:191], v[72:79], v82 abid:1
    ds_read_b128 v[44:47], v12 offset:22528
    s_waitcnt lgkmcnt(6)
    v_smfmac_f32_16x16x64_bf16 v[96:99], v[192:195], v[16:23], v82
    ds_read_b128 v[48:51], v11 offset:24576
    v_smfmac_f32_16x16x64_bf16 v[100:103], v[196:199], v[16:23], v82 abid:1
    ds_read_b128 v[52:55], v12 offset:24576
    v_xor_b32 v184, v184, v80
    s_waitcnt lgkmcnt(6)
    v_smfmac_f32_16x16x64_bf16 v[104:107], v[192:195], v[24:31], v82
    ds_read_b128 v[56:59], v11 offset:26624
    v_smfmac_f32_16x16x64_bf16 v[108:111], v[196:199], v[24:31], v82 abid:1
    ds_read_b128 v[60:63], v12 offset:26624
    v_xor_b32 v185, v185, v80
    s_waitcnt lgkmcnt(6)
    v_smfmac_f32_16x16x64_bf16 v[112:115], v[192:195], v[32:39], v82
    ds_read_b128 v[64:67], v11 offset:28672
    v_smfmac_f32_16x16x64_bf16 v[116:119], v[196:199], v[32:39], v82 abid:1
    ds_read_b128 v[68:71], v12 offset:28672
    v_xor_b32 v186, v186, v80
    s_waitcnt lgkmcnt(6)
    v_smfmac_f32_16x16x64_bf16 v[120:123], v[192:195], v[40:47], v82
    ds_read_b128 v[72:75], v11 offset:30720
    v_smfmac_f32_16x16x64_bf16 v[124:127], v[196:199], v[40:47], v82 abid:1
    ds_read_b128 v[76:79], v12 offset:30720
    v_xor_b32 v187, v187, v80
    s_waitcnt lgkmcnt(6)
    v_smfmac_f32_16x16x64_bf16 v[128:131], v[192:195], v[48:55], v82
    s_barrier
    ds_read_b128 v[16:19], v11 offset:32768
    v_smfmac_f32_16x16x64_bf16 v[132:135], v[196:199], v[48:55], v82 abid:1
    ds_read_b128 v[20:23], v12 offset:32768
    v_xor_b32 v188, v188, v80
    s_waitcnt lgkmcnt(6)
    v_smfmac_f32_16x16x64_bf16 v[136:139], v[192:195], v[56:63], v82
    ds_read_b128 v[24:27], v11 offset:34816
    v_smfmac_f32_16x16x64_bf16 v[140:143], v[196:199], v[56:63], v82 abid:1
    ds_read_b128 v[28:31], v12 offset:34816
    v_xor_b32 v189, v189, v80
    s_waitcnt lgkmcnt(6)
    v_smfmac_f32_16x16x64_bf16 v[144:147], v[192:195], v[64:71], v82
    ds_read_b128 v[32:35], v11 offset:36864
    v_smfmac_f32_16x16x64_bf16 v[148:151], v[196:199], v[64:71], v82 abid:1
    ds_read_b128 v[36:39], v12 offset:36864
    v_xor_b32 v190, v190, v80
    s_waitcnt lgkmcnt(6)
    v_smfmac_f32_16x16x64_bf16 v[152:155], v[192:195], v[72:79], v82
    ds_read_b128 v[40:43], v11 offset:38912
    v_smfmac_f32_16x16x64_bf16 v[156:159], v[196:199], v[72:79], v82 abid:1
    ds_read_b128 v[44:47], v12 offset:38912
    v_xor_b32 v191, v191, v80
    s_cmp_lg_u32 s91, 0
    s_cbranch_scc1 K_NOGO1
    s_mov_b64 s[64:65], s[36:37]
    s_mov_b32 s66, 256
    s_mov_b32 s67, 0x20000
    v_mov_b32 v81, 1
    s_lshl_b32 s82, s4, 2
    s_waitcnt vmcnt(0)
    s_mov_b64 exec, 1
    buffer_store_dword v81, v10, s[64:67], s82 offen sc1
    s_mov_b64 exec, -1
    .p2align 3
K_NOGO1:
    s_waitcnt lgkmcnt(6)
    v_smfmac_f32_16x16x64_bf16 v[96:99], v[200:203], v[16:23], v82
    ds_read_b128 v[48:51], v11 offset:40960
    v_smfmac_f32_16x16x64_bf16 v[100:103], v[204:207], v[16:23], v82 abid:1
    ds_read_b128 v[52:55], v12 offset:40960
    v_xor_b32 v192, v192, v80
    s_waitcnt lgkmcnt(6)
    v_smfmac_f32_16x16x64_bf16 v[104:107], v[200:203], v[24:31], v82
    ds_read_b128 v[56:59], v11 offset:43008
    v_smfmac_f32_16x16x64_bf16 v[108:111], v[204:207], v[24:31], v82 abid:1
    ds_read_b128 v[60:63], v12 offset:43008
    v_xor_b32 v193, v193, v80
    s_waitcnt lgkmcnt(6)
    v_smfmac_f32_16x16x64_bf16 v[112:115], v[200:203], v[32:39], v82
    ds_read_b128 v[64:67], v11 offset:45056
    v_smfmac_f32_16x16x64_bf16 v[116:119], v[204:207], v[32:39], v82 abid:1
    ds_read_b128 v[68:71], v12 offset:45056
    v_xor_b32 v194, v194, v80
    s_waitcnt lgkmcnt(6)
    v_smfmac_f32_16x16x64_bf16 v[120:123], v[200:203], v[40:47], v82
    ds_read_b128 v[72:75], v11 offset:47104
    v_smfmac_f32_16x16x64_bf16 v[124:127], v[204:207], v[40:47], v82 abid:1
    ds_read_b128 v[76:79], v12 offset:47104
    v_xor_b32 v195, v195, v80
    s_waitcnt lgkmcnt(6)
    v_smfmac_f32_16x16x64_bf16 v[128:131], v[200:203], v[48:55], v82
    s_barrier
    ds_read_b128 v[16:19], v11 offset:49152
    v_smfmac_f32_16x16x64_bf16 v[132:135], v[204:207], v[48:55], v82 abid:1
    ds_read_b128 v[20:23], v12 offset:49152
    v_xor_b32 v196, v196, v80
    s_waitcnt lgkmcnt(6)
    v_smfmac_f32_16x16x64_bf16 v[136:139], v[200:203], v[56:63], v82
    ds_read_b128 v[24:27], v11 offset:51200
    v_smfmac_f32_16x16x64_bf16 v[140:143], v[204:207], v[56:63], v82 abid:1
    ds_read_b128 v[28:31], v12 offset:51200
    v_xor_b32 v197, v197, v80
    s_waitcnt lgkmcnt(6)
    v_smfmac_f32_16x16x64_bf16 v[144:147], v[200:203], v[64:71], v82
    ds_read_b128 v[32:35], v11 offset:53248
    v_smfmac_f32_16x16x64_bf16 v[148:151], v[204:207], v[64:71], v82 abid:1
    ds_read_b128 v[36:39], v12 offset:53248
    v_xor_b32 v198, v198, v80
    s_waitcnt lgkmcnt(6)
    v_smfmac_f32_16x16x64_bf16 v[152:155], v[200:203], v[72:79], v82
    ds_read_b128 v[40:43], v11 offset:55296
    v_smfmac_f32_16x16x64_bf16 v[156:159], v[204:207], v[72:79], v82 abid:1
    ds_read_b128 v[44:47], v12 offset:55296
    v_xor_b32 v199, v199, v80
    s_waitcnt lgkmcnt(6)
    v_smfmac_f32_16x16x64_bf16 v[96:99], v[208:211], v[16:23], v82
    ds_read_b128 v[48:51], v11 offset:57344
    v_smfmac_f32_16x16x64_bf16 v[100:103], v[212:215], v[16:23], v82 abid:1
    ds_read_b128 v[52:55], v12 offset:57344
    v_xor_b32 v200, v200, v80
    s_waitcnt lgkmcnt(6)
    v_smfmac_f32_16x16x64_bf16 v[104:107], v[208:211], v[24:31], v82
    ds_read_b128 v[56:59], v11 offset:59392
    v_smfmac_f32_16x16x64_bf16 v[108:111], v[212:215], v[24:31], v82 abid:1
    ds_read_b128 v[60:63], v12 offset:59392
    v_xor_b32 v201, v201, v80
    s_waitcnt lgkmcnt(6)
    v_smfmac_f32_16x16x64_bf16 v[112:115], v[208:211], v[32:39], v82
    ds_read_b128 v[64:67], v11 offset:61440
    v_smfmac_f32_16x16x64_bf16 v[116:119], v[212:215], v[32:39], v82 abid:1
    ds_read_b128 v[68:71], v12 offset:61440
    v_xor_b32 v202, v202, v80
    s_waitcnt lgkmcnt(6)
    v_smfmac_f32_16x16x64_bf16 v[120:123], v[208:211], v[40:47], v82
    ds_read_b128 v[72:75], v11 offset:63488
    v_smfmac_f32_16x16x64_bf16 v[124:127], v[212:215], v[40:47], v82 abid:1
    ds_read_b128 v[76:79], v12 offset:63488
    v_xor_b32 v203, v203, v80
    s_waitcnt lgkmcnt(6)
    v_smfmac_f32_16x16x64_bf16 v[128:131], v[208:211], v[48:55], v82
    s_barrier
    ds_read_b128 v[16:19], v13 offset:0
    v_smfmac_f32_16x16x64_bf16 v[132:135], v[212:215], v[48:55], v82 abid:1
    ds_read_b128 v[20:23], v14 offset:0
    v_xor_b32 v204, v204, v80
    s_waitcnt lgkmcnt(6)
    v_smfmac_f32_16x16x64_bf16 v[136:139], v[208:211], v[56:63], v82
    ds_read_b128 v[24:27], v13 offset:2048
    v_smfmac_f32_16x16x64_bf16 v[140:143], v[212:215], v[56:63], v82 abid:1
    ds_read_b128 v[28:31], v14 offset:2048
    v_xor_b32 v205, v205, v80
    s_waitcnt lgkmcnt(6)
    v_smfmac_f32_16x16x64_bf16 v[144:147], v[208:211], v[64:71], v82
    ds_read_b128 v[32:35], v13 offset:4096
    v_smfmac_f32_16x16x64_bf16 v[148:151], v[212:215], v[64:71], v82 abid:1
    ds_read_b128 v[36:39], v14 offset:4096
    v_xor_b32 v206, v206, v80
    s_waitcnt lgkmcnt(6)
    v_smfmac_f32_16x16x64_bf16 v[152:155], v[208:211], v[72:79], v82
    ds_read_b128 v[40:43], v13 offset:6144
    v_smfmac_f32_16x16x64_bf16 v[156:159], v[212:215], v[72:79], v82 abid:1
    ds_read_b128 v[44:47], v14 offset:6144
    v_xor_b32 v207, v207, v80
    s_waitcnt lgkmcnt(6)
    v_smfmac_f32_16x16x64_bf16 v[96:99], v[184:187], v[16:23], v82
    ds_read_b128 v[48:51], v13 offset:8192
    v_smfmac_f32_16x16x64_bf16 v[100:103], v[188:191], v[16:23], v82 abid:1
    ds_read_b128 v[52:55], v14 offset:8192
    v_xor_b32 v208, v208, v80
    s_waitcnt lgkmcnt(6)
    v_smfmac_f32_16x16x64_bf16 v[104:107], v[184:187], v[24:31], v82
    ds_read_b128 v[56:59], v13 offset:10240
    v_smfmac_f32_16x16x64_bf16 v[108:111], v[188:191], v[24:31], v82 abid:1
    ds_read_b128 v[60:63], v14 offset:10240
    v_xor_b32 v209, v209, v80
    s_waitcnt lgkmcnt(6)
    v_smfmac_f32_16x16x64_bf16 v[112:115], v[184:187], v[32:39], v82
    ds_read_b128 v[64:67], v13 offset:12288
    v_smfmac_f32_16x16x64_bf16 v[116:119], v[188:191], v[32:39], v82 abid:1
    ds_read_b128 v[68:71], v14 offset:12288
    v_xor_b32 v210, v210, v80
    s_waitcnt lgkmcnt(6)
    v_smfmac_f32_16x16x64_bf16 v[120:123], v[184:187], v[40:47], v82
    ds_read_b128 v[72:75], v13 offset:14336
    v_smfmac_f32_16x16x64_bf16 v[124:127], v[188:191], v[40:47], v82 abid:1
    ds_read_b128 v[76:79], v14 offset:14336
    v_xor_b32 v211, v211, v80
    s_waitcnt lgkmcnt(6)
    v_smfmac_f32_16x16x64_bf16 v[128:131], v[184:187], v[48:55], v82
    s_barrier
    ds_read_b128 v[16:19], v13 offset:16384
    v_smfmac_f32_16x16x64_bf16 v[132:135], v[188:191], v[48:55], v82 abid:1
    ds_read_b128 v[20:23], v14 offset:16384
    v_xor_b32 v212, v212, v80
    s_waitcnt lgkmcnt(6)
    v_smfmac_f32_16x16x64_bf16 v[136:139], v[184:187], v[56:63], v82
    ds_read_b128 v[24:27], v13 offset:18432
    v_smfmac_f32_16x16x64_bf16 v[140:143], v[188:191], v[56:63], v82 abid:1
    ds_read_b128 v[28:31], v14 offset:18432
    v_xor_b32 v213, v213, v80
    s_waitcnt lgkmcnt(6)
    v_smfmac_f32_16x16x64_bf16 v[144:147], v[184:187], v[64:71], v82
    ds_read_b128 v[32:35], v13 offset:20480
    v_smfmac_f32_16x16x64_bf16 v[148:151], v[188:191], v[64:71], v82 abid:1
    ds_read_b128 v[36:39], v14 offset:20480
    v_xor_b32 v214, v214, v80
    s_waitcnt lgkmcnt(6)
    v_smfmac_f32_16x16x64_bf16 v[152:155], v[184:187], v[72:79], v82
    ds_read_b128 v[40:43], v13 offset:22528
    v_smfmac_f32_16x16x64_bf16 v[156:159], v[188:191], v[72:79], v82 abid:1
    ds_read_b128 v[44:47], v14 offset:22528
    v_xor_b32 v215, v215, v80
    s_waitcnt lgkmcnt(6)
    v_smfmac_f32_16x16x64_bf16 v[96:99], v[192:195], v[16:23], v82
    ds_read_b128 v[48:51], v13 offset:24576
    v_smfmac_f32_16x16x64_bf16 v[100:103], v[196:199], v[16:23], v82 abid:1
    ds_read_b128 v[52:55], v14 offset:24576
    s_waitcnt lgkmcnt(6)
    v_smfmac_f32_16x16x64_bf16 v[104:107], v[192:195], v[24:31], v82
    ds_read_b128 v[56:59], v13 offset:26624
    v_smfmac_f32_16x16x64_bf16 v[108:111], v[196:199], v[24:31], v82 abid:1
    ds_read_b128 v[60:63], v14 offset:26624
    s_waitcnt lgkmcnt(6)
    v_smfmac_f32_16x16x64_bf16 v[112:115], v[192:195], v[32:39], v82
    ds_read_b128 v[64:67], v13 offset:28672
    v_smfmac_f32_16x16x64_bf16 v[116:119], v[196:199], v[32:39], v82 abid:1
    ds_read_b128 v[68:71], v14 offset:28672
    s_waitcnt lgkmcnt(6)
    v_smfmac_f32_16x16x64_bf16 v[120:123], v[192:195], v[40:47], v82
    ds_read_b128 v[72:75], v13 offset:30720
    v_smfmac_f32_16x16x64_bf16 v[124:127], v[196:199], v[40:47], v82 abid:1
    ds_read_b128 v[76:79], v14 offset:30720
    s_waitcnt lgkmcnt(6)
    v_smfmac_f32_16x16x64_bf16 v[128:131], v[192:195], v[48:55], v82
    s_barrier
    ds_read_b128 v[16:19], v13 offset:32768
    v_smfmac_f32_16x16x64_bf16 v[132:135], v[196:199], v[48:55], v82 abid:1
    ds_read_b128 v[20:23], v14 offset:32768
    s_waitcnt lgkmcnt(6)
    v_smfmac_f32_16x16x64_bf16 v[136:139], v[192:195], v[56:63], v82
    ds_read_b128 v[24:27], v13 offset:34816
    v_smfmac_f32_16x16x64_bf16 v[140:143], v[196:199], v[56:63], v82 abid:1
    ds_read_b128 v[28:31], v14 offset:34816
    s_waitcnt lgkmcnt(6)
    v_smfmac_f32_16x16x64_bf16 v[144:147], v[192:195], v[64:71], v82
    ds_read_b128 v[32:35], v13 offset:36864
    v_smfmac_f32_16x16x64_bf16 v[148:151], v[196:199], v[64:71], v82 abid:1
    ds_read_b128 v[36:39], v14 offset:36864
    s_waitcnt lgkmcnt(6)
    v_smfmac_f32_16x16x64_bf16 v[152:155], v[192:195], v[72:79], v82
    ds_read_b128 v[40:43], v13 offset:38912
    v_smfmac_f32_16x16x64_bf16 v[156:159], v[196:199], v[72:79], v82 abid:1
    ds_read_b128 v[44:47], v14 offset:38912
    s_waitcnt lgkmcnt(6)
    v_smfmac_f32_16x16x64_bf16 v[96:99], v[200:203], v[16:23], v82
    ds_read_b128 v[48:51], v13 offset:40960
    v_smfmac_f32_16x16x64_bf16 v[100:103], v[204:207], v[16:23], v82 abid:1
    ds_read_b128 v[52:55], v14 offset:40960
    s_waitcnt lgkmcnt(6)
    v_smfmac_f32_16x16x64_bf16 v[104:107], v[200:203], v[24:31], v82
    ds_read_b128 v[56:59], v13 offset:43008
    v_smfmac_f32_16x16x64_bf16 v[108:111], v[204:207], v[24:31], v82 abid:1
    ds_read_b128 v[60:63], v14 offset:43008
    s_waitcnt lgkmcnt(6)
    v_smfmac_f32_16x16x64_bf16 v[112:115], v[200:203], v[32:39], v82
    ds_read_b128 v[64:67], v13 offset:45056
    v_smfmac_f32_16x16x64_bf16 v[116:119], v[204:207], v[32:39], v82 abid:1
    ds_read_b128 v[68:71], v14 offset:45056
    s_waitcnt lgkmcnt(6)
    v_smfmac_f32_16x16x64_bf16 v[120:123], v[200:203], v[40:47], v82
    ds_read_b128 v[72:75], v13 offset:47104
    v_smfmac_f32_16x16x64_bf16 v[124:127], v[204:207], v[40:47], v82 abid:1
    ds_read_b128 v[76:79], v14 offset:47104
    s_waitcnt lgkmcnt(6)
    v_smfmac_f32_16x16x64_bf16 v[128:131], v[200:203], v[48:55], v82
    s_barrier
    ds_read_b128 v[16:19], v13 offset:49152
    v_smfmac_f32_16x16x64_bf16 v[132:135], v[204:207], v[48:55], v82 abid:1
    ds_read_b128 v[20:23], v14 offset:49152
    s_waitcnt lgkmcnt(6)
    v_smfmac_f32_16x16x64_bf16 v[136:139], v[200:203], v[56:63], v82
    ds_read_b128 v[24:27], v13 offset:51200
    v_smfmac_f32_16x16x64_bf16 v[140:143], v[204:207], v[56:63], v82 abid:1
    ds_read_b128 v[28:31], v14 offset:51200
    s_waitcnt lgkmcnt(6)
    v_smfmac_f32_16x16x64_bf16 v[144:147], v[200:203], v[64:71], v82
    ds_read_b128 v[32:35], v13 offset:53248
    v_smfmac_f32_16x16x64_bf16 v[148:151], v[204:207], v[64:71], v82 abid:1
    ds_read_b128 v[36:39], v14 offset:53248
    s_waitcnt lgkmcnt(6)
    v_smfmac_f32_16x16x64_bf16 v[152:155], v[200:203], v[72:79], v82
    ds_read_b128 v[40:43], v13 offset:55296
    v_smfmac_f32_16x16x64_bf16 v[156:159], v[204:207], v[72:79], v82 abid:1
    ds_read_b128 v[44:47], v14 offset:55296
    s_waitcnt lgkmcnt(6)
    v_smfmac_f32_16x16x64_bf16 v[96:99], v[208:211], v[16:23], v82
    ds_read_b128 v[48:51], v13 offset:57344
    v_smfmac_f32_16x16x64_bf16 v[100:103], v[212:215], v[16:23], v82 abid:1
    ds_read_b128 v[52:55], v14 offset:57344
    s_waitcnt lgkmcnt(6)
    v_smfmac_f32_16x16x64_bf16 v[104:107], v[208:211], v[24:31], v82
    ds_read_b128 v[56:59], v13 offset:59392
    v_smfmac_f32_16x16x64_bf16 v[108:111], v[212:215], v[24:31], v82 abid:1
    ds_read_b128 v[60:63], v14 offset:59392
    s_waitcnt lgkmcnt(6)
    v_smfmac_f32_16x16x64_bf16 v[112:115], v[208:211], v[32:39], v82
    ds_read_b128 v[64:67], v13 offset:61440
    v_smfmac_f32_16x16x64_bf16 v[116:119], v[212:215], v[32:39], v82 abid:1
    ds_read_b128 v[68:71], v14 offset:61440
    s_waitcnt lgkmcnt(6)
    v_smfmac_f32_16x16x64_bf16 v[120:123], v[208:211], v[40:47], v82
    ds_read_b128 v[72:75], v13 offset:63488
    v_smfmac_f32_16x16x64_bf16 v[124:127], v[212:215], v[40:47], v82 abid:1
    ds_read_b128 v[76:79], v14 offset:63488
    s_waitcnt vmcnt(0) lgkmcnt(0)
    v_cvt_pk_bf16_f32 v86, v96, v100
    v_pk_add_f32 v[16:17], v[96:97], v[100:101]
    v_pk_add_f32 v[18:19], v[98:99], v[102:103]
    v_pk_add_f32 v[96:97], v[96:97], v[100:101] neg_lo:[0,1] neg_hi:[0,1]
    v_pk_add_f32 v[98:99], v[98:99], v[102:103] neg_lo:[0,1] neg_hi:[0,1]
    v_cvt_pk_bf16_f32 v20, v16, v17
    v_cvt_pk_bf16_f32 v22, v96, v97
    v_cvt_pk_bf16_f32 v23, v98, v99
    v_cvt_pk_bf16_f32 v21, v18, v19
    v_and_b32 v20, v20, v94
    v_bitop3_b32 v22, v22, v94, v85 bitop3:0x6a
    v_xor_b32 v23, v23, v85
    v_cvt_pk_bf16_f32 v87, v104, v108
    v_pk_add_f32 v[24:25], v[104:105], v[108:109]
    v_pk_add_f32 v[26:27], v[106:107], v[110:111]
    v_pk_add_f32 v[104:105], v[104:105], v[108:109] neg_lo:[0,1] neg_hi:[0,1]
    ds_write_b128 v83, v[20:23] offset:0
    v_pk_add_f32 v[106:107], v[106:107], v[110:111] neg_lo:[0,1] neg_hi:[0,1]
    v_cvt_pk_bf16_f32 v28, v24, v25
    v_cvt_pk_bf16_f32 v30, v104, v105
    v_cvt_pk_bf16_f32 v31, v106, v107
    v_cvt_pk_bf16_f32 v29, v26, v27
    v_and_b32 v28, v28, v94
    v_bitop3_b32 v30, v30, v94, v85 bitop3:0x6a
    v_xor_b32 v31, v31, v85
    v_cvt_pk_bf16_f32 v88, v112, v116
    v_pk_add_f32 v[32:33], v[112:113], v[116:117]
    v_pk_add_f32 v[34:35], v[114:115], v[118:119]
    v_pk_add_f32 v[112:113], v[112:113], v[116:117] neg_lo:[0,1] neg_hi:[0,1]
    ds_write_b128 v83, v[28:31] offset:512
    v_pk_add_f32 v[114:115], v[114:115], v[118:119] neg_lo:[0,1] neg_hi:[0,1]
    v_cvt_pk_bf16_f32 v36, v32, v33
    v_cvt_pk_bf16_f32 v38, v112, v113
    v_cvt_pk_bf16_f32 v39, v114, v115
    v_cvt_pk_bf16_f32 v37, v34, v35
    v_and_b32 v36, v36, v94
    v_bitop3_b32 v38, v38, v94, v85 bitop3:0x6a
    v_xor_b32 v39, v39, v85
    v_smfmac_f32_16x16x64_bf16 v[128:131], v[208:211], v[48:55], v82
    v_cvt_pk_bf16_f32 v89, v120, v124
    v_smfmac_f32_16x16x64_bf16 v[132:135], v[212:215], v[48:55], v82 abid:1
    ds_write_b128 v83, v[36:39] offset:1024
    v_pk_add_f32 v[40:41], v[120:121], v[124:125]
    v_pk_add_f32 v[42:43], v[122:123], v[126:127]
    v_pk_add_f32 v[120:121], v[120:121], v[124:125] neg_lo:[0,1] neg_hi:[0,1]
    v_pk_add_f32 v[122:123], v[122:123], v[126:127] neg_lo:[0,1] neg_hi:[0,1]
    v_cvt_pk_bf16_f32 v44, v40, v41
    v_cvt_pk_bf16_f32 v46, v120, v121
    v_cvt_pk_bf16_f32 v47, v122, v123
    v_cvt_pk_bf16_f32 v45, v42, v43
    v_and_b32 v44, v44, v94
    v_bitop3_b32 v46, v46, v94, v85 bitop3:0x6a
    v_xor_b32 v47, v47, v85
    v_smfmac_f32_16x16x64_bf16 v[136:139], v[208:211], v[56:63], v82
    v_cvt_pk_bf16_f32 v90, v128, v132
    v_smfmac_f32_16x16x64_bf16 v[140:143], v[212:215], v[56:63], v82 abid:1
    ds_write_b128 v83, v[44:47] offset:1536
    v_pk_add_f32 v[16:17], v[128:129], v[132:133]
    v_pk_add_f32 v[18:19], v[130:131], v[134:135]
    v_pk_add_f32 v[128:129], v[128:129], v[132:133] neg_lo:[0,1] neg_hi:[0,1]
    v_pk_add_f32 v[130:131], v[130:131], v[134:135] neg_lo:[0,1] neg_hi:[0,1]
    v_cvt_pk_bf16_f32 v20, v16, v17
    v_cvt_pk_bf16_f32 v22, v128, v129
    v_cvt_pk_bf16_f32 v23, v130, v131
    v_cvt_pk_bf16_f32 v21, v18, v19
    v_and_b32 v20, v20, v94
    v_bitop3_b32 v22, v22, v94, v85 bitop3:0x6a
    v_xor_b32 v23, v23, v85
    v_smfmac_f32_16x16x64_bf16 v[144:147], v[208:211], v[64:71], v82
    v_cvt_pk_bf16_f32 v91, v136, v140
    v_smfmac_f32_16x16x64_bf16 v[148:151], v[212:215], v[64:71], v82 abid:1
    ds_write_b128 v83, v[20:23] offset:2048
    v_pk_add_f32 v[24:25], v[136:137], v[140:141]
    v_pk_add_f32 v[26:27], v[138:139], v[142:143]
    v_pk_add_f32 v[136:137], v[136:137], v[140:141] neg_lo:[0,1] neg_hi:[0,1]
    v_pk_add_f32 v[138:139], v[138:139], v[142:143] neg_lo:[0,1] neg_hi:[0,1]
    v_cvt_pk_bf16_f32 v28, v24, v25
    v_cvt_pk_bf16_f32 v30, v136, v137
    v_cvt_pk_bf16_f32 v31, v138, v139
    v_cvt_pk_bf16_f32 v29, v26, v27
    v_and_b32 v28, v28, v94
    v_bitop3_b32 v30, v30, v94, v85 bitop3:0x6a
    v_xor_b32 v31, v31, v85
    v_smfmac_f32_16x16x64_bf16 v[152:155], v[208:211], v[72:79], v82
    v_cvt_pk_bf16_f32 v92, v144, v148
    v_smfmac_f32_16x16x64_bf16 v[156:159], v[212:215], v[72:79], v82 abid:1
    ds_write_b128 v83, v[28:31] offset:2560
    v_pk_add_f32 v[32:33], v[144:145], v[148:149]
    v_pk_add_f32 v[34:35], v[146:147], v[150:151]
    v_pk_add_f32 v[144:145], v[144:145], v[148:149] neg_lo:[0,1] neg_hi:[0,1]
    v_pk_add_f32 v[146:147], v[146:147], v[150:151] neg_lo:[0,1] neg_hi:[0,1]
    v_cvt_pk_bf16_f32 v36, v32, v33
    v_cvt_pk_bf16_f32 v38, v144, v145
    v_cvt_pk_bf16_f32 v39, v146, v147
    v_cvt_pk_bf16_f32 v37, v34, v35
    v_and_b32 v36, v36, v94
    v_bitop3_b32 v38, v38, v94, v85 bitop3:0x6a
    v_xor_b32 v39, v39, v85
    v_cvt_pk_bf16_f32 v93, v152, v156
    v_pk_add_f32 v[40:41], v[152:153], v[156:157]
    v_pk_add_f32 v[42:43], v[154:155], v[158:159]
    v_pk_add_f32 v[152:153], v[152:153], v[156:157] neg_lo:[0,1] neg_hi:[0,1]
    ds_write_b128 v83, v[36:39] offset:3072
    v_pk_add_f32 v[154:155], v[154:155], v[158:159] neg_lo:[0,1] neg_hi:[0,1]
    v_cvt_pk_bf16_f32 v44, v40, v41
    v_cvt_pk_bf16_f32 v46, v152, v153
    v_cvt_pk_bf16_f32 v47, v154, v155
    v_cvt_pk_bf16_f32 v45, v42, v43
    v_and_b32 v44, v44, v94
    v_bitop3_b32 v46, v46, v94, v85 bitop3:0x6a
    v_xor_b32 v47, v47, v85
    ds_write_b128 v83, v[44:47] offset:3584
    ds_read_b64_tr_b16 v[16:17], v84 offset:0
    ds_read_b64_tr_b16 v[18:19], v84 offset:512
    ds_read_b64_tr_b16 v[20:21], v84 offset:4096
    ds_read_b64_tr_b16 v[22:23], v84 offset:4608
    ds_read_b64_tr_b16 v[24:25], v84 offset:1024
    ds_read_b64_tr_b16 v[26:27], v84 offset:1536
    ds_read_b64_tr_b16 v[28:29], v84 offset:5120
    ds_read_b64_tr_b16 v[30:31], v84 offset:5632
    ds_read_b64_tr_b16 v[32:33], v84 offset:2048
    ds_read_b64_tr_b16 v[34:35], v84 offset:2560
    ds_read_b64_tr_b16 v[36:37], v84 offset:6144
    ds_read_b64_tr_b16 v[38:39], v84 offset:6656
    s_waitcnt lgkmcnt(8)
    ds_read_b64_tr_b16 v[40:41], v84 offset:3072
    ds_read_b64_tr_b16 v[42:43], v84 offset:3584
    ds_read_b64_tr_b16 v[44:45], v84 offset:7168
    ds_read_b64_tr_b16 v[46:47], v84 offset:7680
    s_waitcnt lgkmcnt(12)
    v_mfma_f32_16x16x32_bf16 v[96:99], v[160:163], v[16:19], 0
    v_mfma_f32_16x16x32_bf16 v[100:103], v[168:171], v[16:19], 0
    v_mfma_f32_16x16x32_bf16 v[96:99], v[168:171], v[20:23], v[96:99]
    v_mfma_f32_16x16x32_bf16 v[100:103], v[176:179], v[20:23], v[100:103]
    s_waitcnt lgkmcnt(8)
    v_mfma_f32_16x16x32_bf16 v[112:115], v[160:163], v[24:27], 0
    v_mfma_f32_16x16x32_bf16 v[116:119], v[168:171], v[24:27], 0
    v_mfma_f32_16x16x32_bf16 v[112:115], v[168:171], v[28:31], v[112:115]
    v_mfma_f32_16x16x32_bf16 v[116:119], v[176:179], v[28:31], v[116:119]
    s_waitcnt lgkmcnt(4)
    v_mfma_f32_16x16x32_bf16 v[128:131], v[160:163], v[32:35], 0
    v_mfma_f32_16x16x32_bf16 v[132:135], v[168:171], v[32:35], 0
    v_mfma_f32_16x16x32_bf16 v[128:131], v[168:171], v[36:39], v[128:131]
    v_mfma_f32_16x16x32_bf16 v[132:135], v[176:179], v[36:39], v[132:135]
    s_waitcnt lgkmcnt(0)
    v_mfma_f32_16x16x32_bf16 v[144:147], v[160:163], v[40:43], 0
    v_cvt_pk_bf16_f32 v48, v96, v112
    v_cvt_pk_bf16_f32 v50, v100, v116
    v_mfma_f32_16x16x32_bf16 v[148:151], v[168:171], v[40:43], 0
    v_cvt_pk_bf16_f32 v52, v97, v113
    v_cvt_pk_bf16_f32 v54, v101, v117
    v_mfma_f32_16x16x32_bf16 v[144:147], v[168:171], v[44:47], v[144:147]
    v_cvt_pk_bf16_f32 v56, v98, v114
    v_cvt_pk_bf16_f32 v58, v102, v118
    v_mfma_f32_16x16x32_bf16 v[148:151], v[176:179], v[44:47], v[148:151]
    v_cvt_pk_bf16_f32 v60, v99, v115
    v_cvt_pk_bf16_f32 v62, v103, v119
    v_mfma_f32_16x16x32_bf16 v[104:107], v[164:167], v[16:19], 0
    s_mov_b32 s76, 0
    s_mov_b32 s77, 67584
    v_mfma_f32_16x16x32_bf16 v[108:111], v[172:175], v[16:19], 0
    v_cvt_pk_bf16_f32 v49, v128, v144
    v_cvt_pk_bf16_f32 v53, v129, v145
    v_mfma_f32_16x16x32_bf16 v[120:123], v[164:167], v[24:27], 0
    v_cvt_pk_bf16_f32 v51, v132, v148
    v_cvt_pk_bf16_f32 v55, v133, v149
    v_mfma_f32_16x16x32_bf16 v[124:127], v[172:175], v[24:27], 0
    v_cvt_pk_bf16_f32 v57, v130, v146
    v_cvt_pk_bf16_f32 v59, v134, v150
    v_mfma_f32_16x16x32_bf16 v[136:139], v[164:167], v[32:35], 0
    v_cvt_pk_bf16_f32 v61, v131, v147
    v_cvt_pk_bf16_f32 v63, v135, v151
    v_mfma_f32_16x16x32_bf16 v[140:143], v[172:175], v[32:35], 0
    buffer_store_dwordx4 v[48:51], v252, s[60:63], s76 offen sc1
    buffer_store_dwordx4 v[52:55], v252, s[60:63], s77 offen sc1
    v_mfma_f32_16x16x32_bf16 v[152:155], v[164:167], v[40:43], 0
    s_mov_b32 s76, 135168
    buffer_store_dwordx4 v[56:59], v252, s[60:63], s76 offen sc1
    v_mfma_f32_16x16x32_bf16 v[156:159], v[172:175], v[40:43], 0
    s_mov_b32 s77, 202752
    buffer_store_dwordx4 v[60:63], v252, s[60:63], s77 offen sc1
    v_mfma_f32_16x16x32_bf16 v[104:107], v[172:175], v[20:23], v[104:107]
    s_mov_b32 s76, 1081344
    s_mov_b32 s77, 1148928
    v_mfma_f32_16x16x32_bf16 v[108:111], v[180:183], v[20:23], v[108:111]
    v_mfma_f32_16x16x32_bf16 v[120:123], v[172:175], v[28:31], v[120:123]
    v_mfma_f32_16x16x32_bf16 v[124:127], v[180:183], v[28:31], v[124:127]
    v_mfma_f32_16x16x32_bf16 v[136:139], v[172:175], v[36:39], v[136:139]
    v_mfma_f32_16x16x32_bf16 v[140:143], v[180:183], v[36:39], v[140:143]
    s_nop 4
    v_cvt_pk_bf16_f32 v64, v104, v120
    v_cvt_pk_bf16_f32 v68, v105, v121
    v_mfma_f32_16x16x32_bf16 v[152:155], v[172:175], v[44:47], v[152:155]
    v_cvt_pk_bf16_f32 v66, v108, v124
    v_cvt_pk_bf16_f32 v70, v109, v125
    v_mfma_f32_16x16x32_bf16 v[156:159], v[180:183], v[44:47], v[156:159]
    v_cvt_pk_bf16_f32 v72, v106, v122
    v_cvt_pk_bf16_f32 v74, v110, v126
    v_cvt_pk_bf16_f32 v76, v107, v123
    v_cvt_pk_bf16_f32 v78, v111, v127
    s_nop 0
    v_cvt_pk_bf16_f32 v65, v136, v152
    v_cvt_pk_bf16_f32 v69, v137, v153
    v_cvt_pk_bf16_f32 v73, v138, v154
    v_cvt_pk_bf16_f32 v77, v139, v155
    v_cvt_pk_bf16_f32 v67, v140, v156
    v_cvt_pk_bf16_f32 v71, v141, v157
    v_cvt_pk_bf16_f32 v75, v142, v158
    v_cvt_pk_bf16_f32 v79, v143, v159
    buffer_store_dwordx4 v[64:67], v252, s[60:63], s76 offen sc1
    buffer_store_dwordx4 v[68:71], v252, s[60:63], s77 offen sc1
    s_mov_b32 s76, 1216512
    buffer_store_dwordx4 v[72:75], v252, s[60:63], s76 offen sc1
    s_mov_b32 s77, 1284096
    buffer_store_dwordx4 v[76:79], v252, s[60:63], s77 offen sc1
    s_cmp_lg_u32 s10, 0
    s_cbranch_scc1 K_NONYQ
    v_and_b32 v184, 15, v1
    v_lshlrev_b32 v185, 5, v184
    v_lshrrev_b32 v186, 2, v1
    v_and_b32 v187, 3, v1
    v_lshlrev_b32 v187, 3, v187
    v_lshl_or_b32 v186, v186, 5, v187
    s_mov_b32 exec_lo, 0
    s_mov_b32 exec_hi, 0xffff
    ds_write_b16 v185, v86 offset:0
    ds_write_b16_d16_hi v185, v86 offset:1024
    ds_write_b16 v185, v87 offset:512
    ds_write_b16_d16_hi v185, v87 offset:1536
    ds_write_b16 v185, v88 offset:2
    ds_write_b16_d16_hi v185, v88 offset:1026
    ds_write_b16 v185, v89 offset:514
    ds_write_b16_d16_hi v185, v89 offset:1538
    ds_write_b16 v185, v90 offset:4
    ds_write_b16_d16_hi v185, v90 offset:1028
    ds_write_b16 v185, v91 offset:516
    ds_write_b16_d16_hi v185, v91 offset:1540
    ds_write_b16 v185, v92 offset:6
    ds_write_b16_d16_hi v185, v92 offset:1030
    ds_write_b16 v185, v93 offset:518
    ds_write_b16_d16_hi v185, v93 offset:1542
    s_mov_b64 exec, -1
    ds_read_b64_tr_b16 v[188:189], v186 offset:0
    ds_read_b64_tr_b16 v[190:191], v186 offset:512
    ds_read_b64_tr_b16 v[192:193], v186 offset:1024
    ds_read_b64_tr_b16 v[194:195], v186 offset:1536
    s_waitcnt lgkmcnt(0)
    v_mfma_f32_16x16x32_bf16 v[196:199], v[188:191], v[160:163], 0
    v_mfma_f32_16x16x32_bf16 v[200:203], v[188:191], v[168:171], 0
    v_mfma_f32_16x16x32_bf16 v[204:207], v[188:191], v[164:167], 0
    v_mfma_f32_16x16x32_bf16 v[208:211], v[188:191], v[172:175], 0
    v_mfma_f32_16x16x32_bf16 v[196:199], v[192:195], v[168:171], v[196:199]
    v_mfma_f32_16x16x32_bf16 v[200:203], v[192:195], v[176:179], v[200:203]
    v_mfma_f32_16x16x32_bf16 v[204:207], v[192:195], v[172:175], v[204:207]
    v_mfma_f32_16x16x32_bf16 v[208:211], v[192:195], v[180:183], v[208:211]
    s_mov_b32 exec_lo, 0xffff
    s_mov_b32 exec_hi, 0
    s_nop 2
    v_cvt_pk_bf16_f32 v212, v196, v197
    v_cvt_pk_bf16_f32 v213, v198, v199
    v_cvt_pk_bf16_f32 v214, v200, v201
    v_cvt_pk_bf16_f32 v215, v202, v203
    s_mov_b32 s76, 0
    buffer_store_dwordx4 v[212:215], v253, s[60:63], s76 offen sc1
    v_cvt_pk_bf16_f32 v216, v204, v205
    v_cvt_pk_bf16_f32 v217, v206, v207
    v_cvt_pk_bf16_f32 v218, v208, v209
    v_cvt_pk_bf16_f32 v219, v210, v211
    s_mov_b32 s76, 256
    buffer_store_dwordx4 v[216:219], v253, s[60:63], s76 offen sc1
    s_mov_b64 exec, -1
K_NONYQ:
    s_waitcnt vmcnt(0)
    s_barrier
    v_cvt_f32_u32 v26, v9
    v_mul_f32 v26, s87, v26
    v_lshrrev_b32 v27, 5, v1
    v_cvt_f32_u32 v27, v27
    v_mul_f32 v27, 4.0, v27
    v_mul_f32 v27, v27, v26
    v_mul_f32 v28, 0x41000000, v26
    v_add_f32 v29, v27, v26
    v_fma_f32 v30, v26, 2.0, v27
    v_fma_f32 v31, v26, 2.0, v29
    v_cos_f32 v32, v27
    v_sin_f32 v36, v27
    v_cos_f32 v33, v29
    v_sin_f32 v37, v29
    v_cos_f32 v34, v30
    v_sin_f32 v38, v30
    v_cos_f32 v35, v31
    v_sin_f32 v39, v31
    v_cvt_pk_bf16_f32 v220, v32, v33
    v_cvt_pk_bf16_f32 v221, v34, v35
    v_cvt_pk_bf16_f32 v222, v36, v37
    v_cvt_pk_bf16_f32 v223, v38, v39
    v_add_f32 v27, v27, v28
    v_add_f32 v29, v27, v26
    v_fma_f32 v30, v26, 2.0, v27
    v_fma_f32 v31, v26, 2.0, v29
    v_cos_f32 v32, v27
    v_sin_f32 v36, v27
    v_cos_f32 v33, v29
    v_sin_f32 v37, v29
    v_cos_f32 v34, v30
    v_sin_f32 v38, v30
    v_cos_f32 v35, v31
    v_sin_f32 v39, v31
    v_cvt_pk_bf16_f32 v224, v32, v33
    v_cvt_pk_bf16_f32 v225, v34, v35
    v_cvt_pk_bf16_f32 v226, v36, v37
    v_cvt_pk_bf16_f32 v227, v38, v39
    v_add_f32 v27, v27, v28
    v_add_f32 v29, v27, v26
    v_fma_f32 v30, v26, 2.0, v27
    v_fma_f32 v31, v26, 2.0, v29
    v_cos_f32 v32, v27
    v_sin_f32 v36, v27
    v_cos_f32 v33, v29
    v_sin_f32 v37, v29
    v_cos_f32 v34, v30
    v_sin_f32 v38, v30
    v_cos_f32 v35, v31
    v_sin_f32 v39, v31
    v_cvt_pk_bf16_f32 v228, v32, v33
    v_cvt_pk_bf16_f32 v229, v34, v35
    v_cvt_pk_bf16_f32 v230, v36, v37
    v_cvt_pk_bf16_f32 v231, v38, v39
    v_add_f32 v27, v27, v28
    v_add_f32 v29, v27, v26
    v_fma_f32 v30, v26, 2.0, v27
    v_fma_f32 v31, v26, 2.0, v29
    v_cos_f32 v32, v27
    v_sin_f32 v36, v27
    v_cos_f32 v33, v29
    v_sin_f32 v37, v29
    v_cos_f32 v34, v30
    v_sin_f32 v38, v30
    v_cos_f32 v35, v31
    v_sin_f32 v39, v31
    v_cvt_pk_bf16_f32 v232, v32, v33
    v_cvt_pk_bf16_f32 v233, v34, v35
    v_cvt_pk_bf16_f32 v234, v36, v37
    v_cvt_pk_bf16_f32 v235, v38, v39
    v_add_f32 v27, v27, v28
    v_add_f32 v29, v27, v26
    v_fma_f32 v30, v26, 2.0, v27
    v_fma_f32 v31, v26, 2.0, v29
    v_cos_f32 v32, v27
    v_sin_f32 v36, v27
    v_cos_f32 v33, v29
    v_sin_f32 v37, v29
    v_cos_f32 v34, v30
    v_sin_f32 v38, v30
    v_cos_f32 v35, v31
    v_sin_f32 v39, v31
    v_cvt_pk_bf16_f32 v236, v32, v33
    v_cvt_pk_bf16_f32 v237, v34, v35
    v_cvt_pk_bf16_f32 v238, v36, v37
    v_cvt_pk_bf16_f32 v239, v38, v39
    v_add_f32 v27, v27, v28
    v_add_f32 v29, v27, v26
    v_fma_f32 v30, v26, 2.0, v27
    v_fma_f32 v31, v26, 2.0, v29
    v_cos_f32 v32, v27
    v_sin_f32 v36, v27
    v_cos_f32 v33, v29
    v_sin_f32 v37, v29
    v_cos_f32 v34, v30
    v_sin_f32 v38, v30
    v_cos_f32 v35, v31
    v_sin_f32 v39, v31
    v_cvt_pk_bf16_f32 v240, v32, v33
    v_cvt_pk_bf16_f32 v241, v34, v35
    v_cvt_pk_bf16_f32 v242, v36, v37
    v_cvt_pk_bf16_f32 v243, v38, v39
    v_add_f32 v27, v27, v28
    v_add_f32 v29, v27, v26
    v_fma_f32 v30, v26, 2.0, v27
    v_fma_f32 v31, v26, 2.0, v29
    v_cos_f32 v32, v27
    v_sin_f32 v36, v27
    v_cos_f32 v33, v29
    v_sin_f32 v37, v29
    v_cos_f32 v34, v30
    v_sin_f32 v38, v30
    v_cos_f32 v35, v31
    v_sin_f32 v39, v31
    v_cvt_pk_bf16_f32 v244, v32, v33
    v_cvt_pk_bf16_f32 v245, v34, v35
    v_cvt_pk_bf16_f32 v246, v36, v37
    v_cvt_pk_bf16_f32 v247, v38, v39
    v_add_f32 v27, v27, v28
    v_add_f32 v29, v27, v26
    v_fma_f32 v30, v26, 2.0, v27
    v_fma_f32 v31, v26, 2.0, v29
    v_cos_f32 v32, v27
    v_sin_f32 v36, v27
    v_cos_f32 v33, v29
    v_sin_f32 v37, v29
    v_cos_f32 v34, v30
    v_sin_f32 v38, v30
    v_cos_f32 v35, v31
    v_sin_f32 v39, v31
    v_cvt_pk_bf16_f32 v248, v32, v33
    v_cvt_pk_bf16_f32 v249, v34, v35
    v_cvt_pk_bf16_f32 v250, v36, v37
    v_cvt_pk_bf16_f32 v251, v38, v39
    v_xor_b32 v209, 32, v3
    v_xor_b32 v210, 64, v3
    v_xor_b32 v211, 96, v3
    s_branch K_RDB
    .p2alignl 12, 0xbf810000
    .fill 182, 4, 0xbf810000
K_QKV:
    s_mov_b32 s86, s9
    s_and_b32 s6, s5, 7
    s_lshr_b32 s7, s5, 3
    s_lshl_b32 s8, s4, 1
    s_lshr_b32 s9, s7, 1
    s_add_u32 s8, s8, s9
    s_sub_u32 s9, 32, s8
    s_cmp_eq_u32 s8, 0
    s_cselect_b32 s9, 16, s9
    s_bitcmp1_b32 s7, 0
    s_cselect_b32 s8, s9, s8
    s_mov_b32 s88, 0x3a000000
    s_mov_b32 s89, 0xba000000
    s_cmp_ge_u32 s6, 4
    s_cselect_b32 s87, s88, s89
    s_lshr_b32 s78, s3, 1
    s_and_b32 s79, s3, 1
    v_and_b32 v22, 31, v1
    v_lshrrev_b32 v23, 5, v1
    s_lshl_b32 s76, s78, 5
    v_add_u32 v24, s76, v22
    v_lshlrev_b32 v25, 5, v24
    v_add_u32 v9, s8, v25
    s_lshl_b32 s76, s8, 8
    v_lshl_add_u32 v2, v24, 2, s76
    s_lshl_b32 s76, s8, 10
    v_and_b32 v26, 1, v24
    v_lshlrev_b32 v26, 9, v26
    v_lshrrev_b32 v27, 4, v24
    v_lshl_add_u32 v26, v27, 7, v26
    v_and_b32 v27, 14, v24
    v_lshl_add_u32 v26, v27, 1, v26
    v_add_u32 v2, s76, v26
    v_lshrrev_b32 v26, 2, v20
    v_lshl_add_u32 v26, v23, 3, v26
    v_lshlrev_b32 v26, 7, v26
    v_lshrrev_b32 v27, 3, v20
    v_xor_b32 v27, s79, v27
    v_lshl_add_u32 v26, v27, 6, v26
    v_and_b32 v27, 1, v21
    v_lshl_add_u32 v26, v27, 5, v26
    v_and_b32 v27, 3, v1
    v_lshl_add_u32 v26, v27, 3, v26
    v_add_u32 v8, 81920, v26
    v_bfe_u32 v26, v22, 1, 3
    v_xor_b32 v26, v26, v23
    v_lshlrev_b32 v26, 4, v26
    v_lshl_or_b32 v3, v24, 7, v26
    s_lshl_b32 s76, s79, 9
    s_add_u32 s76, s76, 147456
    v_lshlrev_b32 v26, 4, v22
    v_lshl_add_u32 v26, v23, 10, v26
    v_add_u32 v4, s76, v26
    s_lshl_b32 s76, s3, 11
    v_bfe_u32 v26, v22, 1, 2
    v_lshlrev_b32 v26, 4, v26
    v_lshl_or_b32 v26, v22, 6, v26
    v_lshl_or_b32 v26, v23, 3, v26
    v_add_u32 v5, s76, v26
    v_add_u32 v6, s76, v19
    v_lshrrev_b32 v27, 2, v1
    v_xor_b32 v26, v16, v1
    v_and_b32 v26, 3, v26
    v_lshlrev_b32 v26, 4, v26
    v_lshl_add_u32 v26, v27, 15, v26
    s_lshl_b32 s76, s78, 20
    s_lshl_b32 s77, s8, 10
    s_add_u32 s76, s76, s77
    s_lshl_b32 s77, s6, 1
    s_add_u32 s77, s77, s79
    s_lshl_b32 s77, s77, 6
    s_add_u32 s76, s76, s77
    v_add_u32 v7, s76, v26
    s_mov_b32 s9, s86
    v_cvt_f32_u32 v26, v9
    v_mul_f32 v26, s87, v26
    v_lshrrev_b32 v27, 5, v1
    v_cvt_f32_u32 v27, v27
    v_mul_f32 v27, 4.0, v27
    v_mul_f32 v27, v27, v26
    v_mul_f32 v28, 0x41000000, v26
    v_add_f32 v29, v27, v26
    v_fma_f32 v30, v26, 2.0, v27
    v_fma_f32 v31, v26, 2.0, v29
    v_cos_f32 v32, v27
    v_sin_f32 v36, v27
    v_cos_f32 v33, v29
    v_sin_f32 v37, v29
    v_cos_f32 v34, v30
    v_sin_f32 v38, v30
    v_cos_f32 v35, v31
    v_sin_f32 v39, v31
    v_cvt_pk_bf16_f32 v220, v32, v33
    v_cvt_pk_bf16_f32 v221, v34, v35
    v_cvt_pk_bf16_f32 v222, v36, v37
    v_cvt_pk_bf16_f32 v223, v38, v39
    v_add_f32 v27, v27, v28
    v_add_f32 v29, v27, v26
    v_fma_f32 v30, v26, 2.0, v27
    v_fma_f32 v31, v26, 2.0, v29
    v_cos_f32 v32, v27
    v_sin_f32 v36, v27
    v_cos_f32 v33, v29
    v_sin_f32 v37, v29
    v_cos_f32 v34, v30
    v_sin_f32 v38, v30
    v_cos_f32 v35, v31
    v_sin_f32 v39, v31
    v_cvt_pk_bf16_f32 v224, v32, v33
    v_cvt_pk_bf16_f32 v225, v34, v35
    v_cvt_pk_bf16_f32 v226, v36, v37
    v_cvt_pk_bf16_f32 v227, v38, v39
    v_add_f32 v27, v27, v28
    v_add_f32 v29, v27, v26
    v_fma_f32 v30, v26, 2.0, v27
    v_fma_f32 v31, v26, 2.0, v29
    v_cos_f32 v32, v27
    v_sin_f32 v36, v27
    v_cos_f32 v33, v29
    v_sin_f32 v37, v29
    v_cos_f32 v34, v30
    v_sin_f32 v38, v30
    v_cos_f32 v35, v31
    v_sin_f32 v39, v31
    v_cvt_pk_bf16_f32 v228, v32, v33
    v_cvt_pk_bf16_f32 v229, v34, v35
    v_cvt_pk_bf16_f32 v230, v36, v37
    v_cvt_pk_bf16_f32 v231, v38, v39
    v_add_f32 v27, v27, v28
    v_add_f32 v29, v27, v26
    v_fma_f32 v30, v26, 2.0, v27
    v_fma_f32 v31, v26, 2.0, v29
    v_cos_f32 v32, v27
    v_sin_f32 v36, v27
    v_cos_f32 v33, v29
    v_sin_f32 v37, v29
    v_cos_f32 v34, v30
    v_sin_f32 v38, v30
    v_cos_f32 v35, v31
    v_sin_f32 v39, v31
    v_cvt_pk_bf16_f32 v232, v32, v33
    v_cvt_pk_bf16_f32 v233, v34, v35
    v_cvt_pk_bf16_f32 v234, v36, v37
    v_cvt_pk_bf16_f32 v235, v38, v39
    v_add_f32 v27, v27, v28
    v_add_f32 v29, v27, v26
    v_fma_f32 v30, v26, 2.0, v27
    v_fma_f32 v31, v26, 2.0, v29
    v_cos_f32 v32, v27
    v_sin_f32 v36, v27
    v_cos_f32 v33, v29
    v_sin_f32 v37, v29
    v_cos_f32 v34, v30
    v_sin_f32 v38, v30
    v_cos_f32 v35, v31
    v_sin_f32 v39, v31
    v_cvt_pk_bf16_f32 v236, v32, v33
    v_cvt_pk_bf16_f32 v237, v34, v35
    v_cvt_pk_bf16_f32 v238, v36, v37
    v_cvt_pk_bf16_f32 v239, v38, v39
    v_add_f32 v27, v27, v28
    v_add_f32 v29, v27, v26
    v_fma_f32 v30, v26, 2.0, v27
    v_fma_f32 v31, v26, 2.0, v29
    v_cos_f32 v32, v27
    v_sin_f32 v36, v27
    v_cos_f32 v33, v29
    v_sin_f32 v37, v29
    v_cos_f32 v34, v30
    v_sin_f32 v38, v30
    v_cos_f32 v35, v31
    v_sin_f32 v39, v31
    v_cvt_pk_bf16_f32 v240, v32, v33
    v_cvt_pk_bf16_f32 v241, v34, v35
    v_cvt_pk_bf16_f32 v242, v36, v37
    v_cvt_pk_bf16_f32 v243, v38, v39
    v_add_f32 v27, v27, v28
    v_add_f32 v29, v27, v26
    v_fma_f32 v30, v26, 2.0, v27
    v_fma_f32 v31, v26, 2.0, v29
    v_cos_f32 v32, v27
    v_sin_f32 v36, v27
    v_cos_f32 v33, v29
    v_sin_f32 v37, v29
    v_cos_f32 v34, v30
    v_sin_f32 v38, v30
    v_cos_f32 v35, v31
    v_sin_f32 v39, v31
    v_cvt_pk_bf16_f32 v244, v32, v33
    v_cvt_pk_bf16_f32 v245, v34, v35
    v_cvt_pk_bf16_f32 v246, v36, v37
    v_cvt_pk_bf16_f32 v247, v38, v39
    v_add_f32 v27, v27, v28
    v_add_f32 v29, v27, v26
    v_fma_f32 v30, v26, 2.0, v27
    v_fma_f32 v31, v26, 2.0, v29
    v_cos_f32 v32, v27
    v_sin_f32 v36, v27
    v_cos_f32 v33, v29
    v_sin_f32 v37, v29
    v_cos_f32 v34, v30
    v_sin_f32 v38, v30
    v_cos_f32 v35, v31
    v_sin_f32 v39, v31
    v_cvt_pk_bf16_f32 v248, v32, v33
    v_cvt_pk_bf16_f32 v249, v34, v35
    v_cvt_pk_bf16_f32 v250, v36, v37
    v_cvt_pk_bf16_f32 v251, v38, v39
    s_lshr_b32 s8, s4, 1
    s_mul_i32 s8, s8, 6
    s_sub_u32 s8, s8, 2
    s_add_u32 s8, s8, s9
    s_and_b32 s10, s4, 1
    s_lshl_b32 s10, s10, 2
    s_add_u32 s10, s10, s11
    s_lshr_b32 s12, s8, 1
    s_mul_i32 s12, s12, 85
    s_and_b32 s13, s8, 1
    s_lshl_b32 s14, s12, 1
    s_add_u32 s14, s14, s13
    s_lshl_b32 s14, s14, 10
    v_lshrrev_b32 v22, 2, v20
    v_lshl_add_u32 v22, v21, 3, v22
    v_lshlrev_b32 v22, 7, v22
    v_lshrrev_b32 v23, 3, v20
    v_and_b32 v24, 1, v21
    v_lshl_or_b32 v23, v24, 1, v23
    v_xor_b32 v23, s3, v23
    v_lshl_add_u32 v22, v23, 5, v22
    v_and_b32 v23, 3, v20
    v_lshl_add_u32 v22, v23, 3, v22
    v_add_u32 v13, 49152, v22
    v_add_u32 v14, 98304, v22
    v_lshlrev_b32 v22, 2, v21
    v_sub_u32 v22, v20, v22
    v_mov_b32 v24, 0xf149f2ca
    v_mov_b32 v25, 0
    v_subrev_u32 v23, 0, v22
    v_cmp_gt_u32 vcc, 8, v23
    v_cmp_gt_i32 s[76:77], -8, v23
    v_mov_b32 v172, 0x3f803f80
    v_cndmask_b32 v160, v24, v25, vcc
    v_cndmask_b32 v164, v24, v25, s[76:77]
    v_subrev_u32 v23, 1, v22
    v_cmp_gt_u32 vcc, 8, v23
    v_cmp_gt_i32 s[76:77], -8, v23
    v_mov_b32 v173, 0x3f803f80
    v_cndmask_b32 v161, v24, v25, vcc
    v_cndmask_b32 v165, v24, v25, s[76:77]
    v_subrev_u32 v23, 2, v22
    v_cmp_gt_u32 vcc, 8, v23
    v_cmp_gt_i32 s[76:77], -8, v23
    v_mov_b32 v174, 0x3f803f80
    v_cndmask_b32 v162, v24, v25, vcc
    v_cndmask_b32 v166, v24, v25, s[76:77]
    v_subrev_u32 v23, 3, v22
    v_cmp_gt_u32 vcc, 8, v23
    v_cmp_gt_i32 s[76:77], -8, v23
    v_mov_b32 v175, 0x3f803f80
    v_cndmask_b32 v163, v24, v25, vcc
    v_cndmask_b32 v167, v24, v25, s[76:77]
    v_mov_b32 v26, 0xffff
    v_mov_b32 v27, 0xffff0000
    v_cmp_le_i32 vcc, 0, v22
    v_cmp_le_i32 s[76:77], 1, v22
    s_nop 0
    v_cndmask_b32 v28, v25, v26, vcc
    v_cndmask_b32 v29, v25, v27, s[76:77]
    v_or_b32 v168, v28, v29
    v_cmp_le_i32 vcc, 2, v22
    v_cmp_le_i32 s[76:77], 3, v22
    s_nop 0
    v_cndmask_b32 v28, v25, v26, vcc
    v_cndmask_b32 v29, v25, v27, s[76:77]
    v_or_b32 v169, v28, v29
    v_lshrrev_b32 v22, 1, v21
    s_lshl_b32 s76, s3, 1
    v_add_u32 v22, s76, v22
    v_and_b32 v23, 7, v20
    v_xor_b32 v22, v22, v23
    v_lshlrev_b32 v22, 4, v22
    v_lshl_or_b32 v22, v20, 7, v22
    v_and_b32 v23, 1, v21
    v_lshl_or_b32 v176, v23, 3, v22
    s_mul_i32 s76, s3, 3072
    v_add_u32 v177, s76, v19
    v_xor_b32 v22, v17, v16
    v_lshlrev_b32 v22, 4, v22
    s_mul_i32 s76, s10, 262272
    s_lshl_b32 s77, s13, 10
    s_add_u32 s77, s77, s12
    s_lshl_b32 s77, s77, 7
    s_add_u32 s76, s76, s77
    v_add_u32 v22, s76, v22
    s_cmp_eq_u32 s12, 0
    s_cselect_b32 s77, 0, 11
    s_sub_u32 s78, 1024, s12
    s_sub_u32 s78, s78, s77
    s_mul_i32 s76, s3, 24
    v_mov_b32 v24, 0x80000000
    v_add_u32 v23, s76, v16
    v_lshl_add_u32 v26, v23, 7, v22
    v_subrev_u32 v23, s77, v23
    v_cmp_gt_u32 vcc, s78, v23
    s_nop 1
    v_cndmask_b32 v178, v24, v26, vcc
    v_add_u32 v23, s76, v16
    v_add_u32 v23, 8, v23
    v_lshl_add_u32 v26, v23, 7, v22
    v_subrev_u32 v23, s77, v23
    v_cmp_gt_u32 vcc, s78, v23
    s_nop 1
    v_cndmask_b32 v179, v24, v26, vcc
    v_add_u32 v23, s76, v16
    v_add_u32 v23, 16, v23
    v_lshl_add_u32 v26, v23, 7, v22
    v_subrev_u32 v23, s77, v23
    v_cmp_gt_u32 vcc, s78, v23
    s_nop 1
    v_cndmask_b32 v180, v24, v26, vcc
    s_mov_b32 s94, 0x3eb8aa3b
    s_mov_b32 s95, 0x3eb8aa3b
    .p2align 3
    s_barrier
    s_nop 0
    ds_read_b64_tr_b16 v[64:65], v13 offset:24576
    ds_read_b64_tr_b16 v[66:67], v13 offset:25088
    ds_read_b128 v[16:19], v11 offset:12288
    ds_read_b64_tr_b16 v[68:69], v13 offset:32768
    ds_read_b64_tr_b16 v[70:71], v13 offset:33280
    ds_read_b64_tr_b16 v[72:73], v13 offset:40960
    ds_read_b64_tr_b16 v[74:75], v13 offset:41472
    ds_read_b128 v[20:23], v11 offset:14336
    ds_read_b128 v[24:27], v11 offset:16384
    ds_read_b128 v[28:31], v11 offset:18432
    ds_read_b128 v[32:35], v11 offset:20480
    ds_read_b128 v[36:39], v11 offset:22528
    s_waitcnt lgkmcnt(0)
    s_nop 0
    v_mfma_f32_16x16x32_bf16 v[88:91], v[64:67], v[16:19], 0
    ds_read_b64_tr_b16 v[76:77], v13 offset:28672
    v_mfma_f32_16x16x32_bf16 v[92:95], v[68:71], v[16:19], 0
    ds_read_b64_tr_b16 v[78:79], v13 offset:29184
    v_mfma_f32_16x16x32_bf16 v[96:99], v[16:19], v[72:75], 0
    ds_read_b128 v[40:43], v12 offset:12288
    v_mfma_f32_16x16x32_bf16 v[100:103], v[64:67], v[20:23], 0
    ds_read_b64_tr_b16 v[80:81], v13 offset:36864
    v_mfma_f32_16x16x32_bf16 v[104:107], v[68:71], v[20:23], 0
    ds_read_b64_tr_b16 v[82:83], v13 offset:37376
    v_mfma_f32_16x16x32_bf16 v[108:111], v[20:23], v[72:75], 0
    ds_read_b64_tr_b16 v[84:85], v13 offset:45056
    v_mfma_f32_16x16x32_bf16 v[112:115], v[64:67], v[24:27], 0
    ds_read_b64_tr_b16 v[86:87], v13 offset:45568
    v_mfma_f32_16x16x32_bf16 v[116:119], v[68:71], v[24:27], 0
    ds_read_b128 v[44:47], v12 offset:14336
    v_mfma_f32_16x16x32_bf16 v[120:123], v[24:27], v[72:75], 0
    ds_read_b128 v[48:51], v12 offset:16384
    v_mfma_f32_16x16x32_bf16 v[124:127], v[64:67], v[28:31], 0
    ds_read_b128 v[52:55], v12 offset:18432
    v_mfma_f32_16x16x32_bf16 v[128:131], v[68:71], v[28:31], 0
    ds_read_b128 v[56:59], v12 offset:20480
    v_mfma_f32_16x16x32_bf16 v[132:135], v[28:31], v[72:75], 0
    ds_read_b128 v[60:63], v12 offset:22528
    v_mfma_f32_16x16x32_bf16 v[136:139], v[64:67], v[32:35], 0
    v_mfma_f32_16x16x32_bf16 v[140:143], v[68:71], v[32:35], 0
    v_mfma_f32_16x16x32_bf16 v[144:147], v[32:35], v[72:75], 0
    v_mfma_f32_16x16x32_bf16 v[148:151], v[64:67], v[36:39], 0
    v_mfma_f32_16x16x32_bf16 v[152:155], v[68:71], v[36:39], 0
    v_mfma_f32_16x16x32_bf16 v[156:159], v[36:39], v[72:75], 0
    s_waitcnt lgkmcnt(0)
    s_barrier
    v_mfma_f32_16x16x32_bf16 v[88:91], v[76:79], v[40:43], v[88:91]
    ds_read_b64_tr_b16 v[64:65], v14 offset:0
    v_mfma_f32_16x16x32_bf16 v[92:95], v[80:83], v[40:43], v[92:95]
    ds_read_b64_tr_b16 v[66:67], v14 offset:512
    v_mfma_f32_16x16x32_bf16 v[96:99], v[40:43], v[84:87], v[96:99]
    ds_read_b128 v[16:19], v11 offset:24576
    v_mfma_f32_16x16x32_bf16 v[100:103], v[76:79], v[44:47], v[100:103]
    ds_read_b64_tr_b16 v[68:69], v14 offset:8192
    v_mfma_f32_16x16x32_bf16 v[104:107], v[80:83], v[44:47], v[104:107]
    ds_read_b64_tr_b16 v[70:71], v14 offset:8704
    v_mfma_f32_16x16x32_bf16 v[108:111], v[44:47], v[84:87], v[108:111]
    ds_read_b64_tr_b16 v[72:73], v14 offset:16384
    v_mfma_f32_16x16x32_bf16 v[112:115], v[76:79], v[48:51], v[112:115]
    ds_read_b64_tr_b16 v[74:75], v14 offset:16896
    v_mfma_f32_16x16x32_bf16 v[116:119], v[80:83], v[48:51], v[116:119]
    ds_read_b128 v[20:23], v11 offset:26624
    v_mfma_f32_16x16x32_bf16 v[120:123], v[48:51], v[84:87], v[120:123]
    ds_read_b128 v[24:27], v11 offset:28672
    v_mfma_f32_16x16x32_bf16 v[124:127], v[76:79], v[52:55], v[124:127]
    ds_read_b128 v[28:31], v11 offset:30720
    v_mfma_f32_16x16x32_bf16 v[128:131], v[80:83], v[52:55], v[128:131]
    ds_read_b128 v[32:35], v11 offset:32768
    v_mfma_f32_16x16x32_bf16 v[132:135], v[52:55], v[84:87], v[132:135]
    ds_read_b128 v[36:39], v11 offset:34816
    v_mfma_f32_16x16x32_bf16 v[136:139], v[76:79], v[56:59], v[136:139]
    v_mfma_f32_16x16x32_bf16 v[140:143], v[80:83], v[56:59], v[140:143]
    v_mfma_f32_16x16x32_bf16 v[144:147], v[56:59], v[84:87], v[144:147]
    v_mfma_f32_16x16x32_bf16 v[148:151], v[76:79], v[60:63], v[148:151]
    v_mfma_f32_16x16x32_bf16 v[152:155], v[80:83], v[60:63], v[152:155]
    v_mfma_f32_16x16x32_bf16 v[156:159], v[60:63], v[84:87], v[156:159]
    s_waitcnt lgkmcnt(0)
    s_nop 0
    v_mfma_f32_16x16x32_bf16 v[88:91], v[64:67], v[16:19], v[88:91]
    ds_read_b64_tr_b16 v[76:77], v14 offset:4096
    v_mfma_f32_16x16x32_bf16 v[92:95], v[68:71], v[16:19], v[92:95]
    ds_read_b64_tr_b16 v[78:79], v14 offset:4608
    v_mfma_f32_16x16x32_bf16 v[96:99], v[16:19], v[72:75], v[96:99]
    ds_read_b128 v[40:43], v12 offset:24576
    v_mfma_f32_16x16x32_bf16 v[100:103], v[64:67], v[20:23], v[100:103]
    ds_read_b64_tr_b16 v[80:81], v14 offset:12288
    v_mfma_f32_16x16x32_bf16 v[104:107], v[68:71], v[20:23], v[104:107]
    ds_read_b64_tr_b16 v[82:83], v14 offset:12800
    v_mfma_f32_16x16x32_bf16 v[108:111], v[20:23], v[72:75], v[108:111]
    ds_read_b64_tr_b16 v[84:85], v14 offset:20480
    v_mfma_f32_16x16x32_bf16 v[112:115], v[64:67], v[24:27], v[112:115]
    ds_read_b64_tr_b16 v[86:87], v14 offset:20992
    v_mfma_f32_16x16x32_bf16 v[116:119], v[68:71], v[24:27], v[116:119]
    ds_read_b128 v[44:47], v12 offset:26624
    v_mfma_f32_16x16x32_bf16 v[120:123], v[24:27], v[72:75], v[120:123]
    ds_read_b128 v[48:51], v12 offset:28672
    v_mfma_f32_16x16x32_bf16 v[124:127], v[64:67], v[28:31], v[124:127]
    ds_read_b128 v[52:55], v12 offset:30720
    v_mfma_f32_16x16x32_bf16 v[128:131], v[68:71], v[28:31], v[128:131]
    ds_read_b128 v[56:59], v12 offset:32768
    v_mfma_f32_16x16x32_bf16 v[132:135], v[28:31], v[72:75], v[132:135]
    ds_read_b128 v[60:63], v12 offset:34816
    v_mfma_f32_16x16x32_bf16 v[136:139], v[64:67], v[32:35], v[136:139]
    v_mfma_f32_16x16x32_bf16 v[140:143], v[68:71], v[32:35], v[140:143]
    v_mfma_f32_16x16x32_bf16 v[144:147], v[32:35], v[72:75], v[144:147]
    v_mfma_f32_16x16x32_bf16 v[148:151], v[64:67], v[36:39], v[148:151]
    v_mfma_f32_16x16x32_bf16 v[152:155], v[68:71], v[36:39], v[152:155]
    v_mfma_f32_16x16x32_bf16 v[156:159], v[36:39], v[72:75], v[156:159]
    s_waitcnt lgkmcnt(0)
    s_barrier
    v_mfma_f32_16x16x32_bf16 v[88:91], v[76:79], v[40:43], v[88:91]
    ds_read_b64_tr_b16 v[64:65], v14 offset:24576
    v_mfma_f32_16x16x32_bf16 v[92:95], v[80:83], v[40:43], v[92:95]
    ds_read_b64_tr_b16 v[66:67], v14 offset:25088
    v_mfma_f32_16x16x32_bf16 v[96:99], v[40:43], v[84:87], v[96:99]
    ds_read_b128 v[16:19], v11 offset:36864
    v_mfma_f32_16x16x32_bf16 v[100:103], v[76:79], v[44:47], v[100:103]
    ds_read_b64_tr_b16 v[68:69], v14 offset:32768
    v_mfma_f32_16x16x32_bf16 v[104:107], v[80:83], v[44:47], v[104:107]
    ds_read_b64_tr_b16 v[70:71], v14 offset:33280
    v_mfma_f32_16x16x32_bf16 v[108:111], v[44:47], v[84:87], v[108:111]
    ds_read_b64_tr_b16 v[72:73], v14 offset:40960
    v_mfma_f32_16x16x32_bf16 v[112:115], v[76:79], v[48:51], v[112:115]
    ds_read_b64_tr_b16 v[74:75], v14 offset:41472
    v_mfma_f32_16x16x32_bf16 v[116:119], v[80:83], v[48:51], v[116:119]
    ds_read_b128 v[20:23], v11 offset:38912
    v_mfma_f32_16x16x32_bf16 v[120:123], v[48:51], v[84:87], v[120:123]
    ds_read_b128 v[24:27], v11 offset:40960
    v_mfma_f32_16x16x32_bf16 v[124:127], v[76:79], v[52:55], v[124:127]
    ds_read_b128 v[28:31], v11 offset:43008
    v_mfma_f32_16x16x32_bf16 v[128:131], v[80:83], v[52:55], v[128:131]
    ds_read_b128 v[32:35], v11 offset:45056
    v_mfma_f32_16x16x32_bf16 v[132:135], v[52:55], v[84:87], v[132:135]
    ds_read_b128 v[36:39], v11 offset:47104
    v_mfma_f32_16x16x32_bf16 v[136:139], v[76:79], v[56:59], v[136:139]
    v_mfma_f32_16x16x32_bf16 v[140:143], v[80:83], v[56:59], v[140:143]
    v_mfma_f32_16x16x32_bf16 v[144:147], v[56:59], v[84:87], v[144:147]
    v_mfma_f32_16x16x32_bf16 v[148:151], v[76:79], v[60:63], v[148:151]
    v_mfma_f32_16x16x32_bf16 v[152:155], v[80:83], v[60:63], v[152:155]
    v_mfma_f32_16x16x32_bf16 v[156:159], v[60:63], v[84:87], v[156:159]
    s_waitcnt lgkmcnt(0)
    s_nop 0
    v_mfma_f32_16x16x32_bf16 v[88:91], v[64:67], v[16:19], v[88:91]
    ds_read_b64_tr_b16 v[76:77], v14 offset:28672
    v_mfma_f32_16x16x32_bf16 v[92:95], v[68:71], v[16:19], v[92:95]
    ds_read_b64_tr_b16 v[78:79], v14 offset:29184
    v_mfma_f32_16x16x32_bf16 v[96:99], v[16:19], v[72:75], v[96:99]
    ds_read_b128 v[40:43], v12 offset:36864
    v_mfma_f32_16x16x32_bf16 v[100:103], v[64:67], v[20:23], v[100:103]
    ds_read_b64_tr_b16 v[80:81], v14 offset:36864
    v_mfma_f32_16x16x32_bf16 v[104:107], v[68:71], v[20:23], v[104:107]
    ds_read_b64_tr_b16 v[82:83], v14 offset:37376
    v_mfma_f32_16x16x32_bf16 v[108:111], v[20:23], v[72:75], v[108:111]
    ds_read_b64_tr_b16 v[84:85], v14 offset:45056
    v_mfma_f32_16x16x32_bf16 v[112:115], v[64:67], v[24:27], v[112:115]
    ds_read_b64_tr_b16 v[86:87], v14 offset:45568
    v_mfma_f32_16x16x32_bf16 v[116:119], v[68:71], v[24:27], v[116:119]
    ds_read_b128 v[44:47], v12 offset:38912
    v_mfma_f32_16x16x32_bf16 v[120:123], v[24:27], v[72:75], v[120:123]
    ds_read_b128 v[48:51], v12 offset:40960
    v_mfma_f32_16x16x32_bf16 v[124:127], v[64:67], v[28:31], v[124:127]
    ds_read_b128 v[52:55], v12 offset:43008
    v_mfma_f32_16x16x32_bf16 v[128:131], v[68:71], v[28:31], v[128:131]
    ds_read_b128 v[56:59], v12 offset:45056
    v_mfma_f32_16x16x32_bf16 v[132:135], v[28:31], v[72:75], v[132:135]
    ds_read_b128 v[60:63], v12 offset:47104
    v_mfma_f32_16x16x32_bf16 v[136:139], v[64:67], v[32:35], v[136:139]
    v_mfma_f32_16x16x32_bf16 v[140:143], v[68:71], v[32:35], v[140:143]
    v_mfma_f32_16x16x32_bf16 v[144:147], v[32:35], v[72:75], v[144:147]
    v_mfma_f32_16x16x32_bf16 v[148:151], v[64:67], v[36:39], v[148:151]
    v_mfma_f32_16x16x32_bf16 v[152:155], v[68:71], v[36:39], v[152:155]
    v_mfma_f32_16x16x32_bf16 v[156:159], v[36:39], v[72:75], v[156:159]
    s_waitcnt lgkmcnt(0)
    s_barrier
    v_mfma_f32_16x16x32_bf16 v[88:91], v[76:79], v[40:43], v[88:91]
    ds_read_b64_tr_b16 v[64:65], v13 offset:0
    v_mfma_f32_16x16x32_bf16 v[92:95], v[80:83], v[40:43], v[92:95]
    ds_read_b64_tr_b16 v[66:67], v13 offset:512
    v_mfma_f32_16x16x32_bf16 v[96:99], v[40:43], v[84:87], v[96:99]
    ds_read_b128 v[16:19], v11 offset:0
    v_mfma_f32_16x16x32_bf16 v[100:103], v[76:79], v[44:47], v[100:103]
    ds_read_b64_tr_b16 v[68:69], v13 offset:8192
    v_mfma_f32_16x16x32_bf16 v[104:107], v[80:83], v[44:47], v[104:107]
    ds_read_b64_tr_b16 v[70:71], v13 offset:8704
    v_mfma_f32_16x16x32_bf16 v[108:111], v[44:47], v[84:87], v[108:111]
    ds_read_b64_tr_b16 v[72:73], v13 offset:16384
    v_mfma_f32_16x16x32_bf16 v[112:115], v[76:79], v[48:51], v[112:115]
    ds_read_b64_tr_b16 v[74:75], v13 offset:16896
    v_mfma_f32_16x16x32_bf16 v[116:119], v[80:83], v[48:51], v[116:119]
    ds_read_b128 v[20:23], v11 offset:2048
    v_mfma_f32_16x16x32_bf16 v[120:123], v[48:51], v[84:87], v[120:123]
    ds_read_b128 v[24:27], v11 offset:4096
    v_mfma_f32_16x16x32_bf16 v[124:127], v[76:79], v[52:55], v[124:127]
    ds_read_b128 v[28:31], v11 offset:6144
    v_mfma_f32_16x16x32_bf16 v[128:131], v[80:83], v[52:55], v[128:131]
    ds_read_b128 v[32:35], v11 offset:8192
    v_mfma_f32_16x16x32_bf16 v[132:135], v[52:55], v[84:87], v[132:135]
    ds_read_b128 v[36:39], v11 offset:10240
    v_mfma_f32_16x16x32_bf16 v[136:139], v[76:79], v[56:59], v[136:139]
    v_mfma_f32_16x16x32_bf16 v[140:143], v[80:83], v[56:59], v[140:143]
    v_mfma_f32_16x16x32_bf16 v[144:147], v[56:59], v[84:87], v[144:147]
    v_mfma_f32_16x16x32_bf16 v[148:151], v[76:79], v[60:63], v[148:151]
    v_mfma_f32_16x16x32_bf16 v[152:155], v[80:83], v[60:63], v[152:155]
    v_mfma_f32_16x16x32_bf16 v[156:159], v[60:63], v[84:87], v[156:159]
    s_waitcnt lgkmcnt(0)
    s_nop 0
    v_mfma_f32_16x16x32_bf16 v[88:91], v[64:67], v[16:19], v[88:91]
    ds_read_b64_tr_b16 v[76:77], v13 offset:4096
    v_mfma_f32_16x16x32_bf16 v[92:95], v[68:71], v[16:19], v[92:95]
    ds_read_b64_tr_b16 v[78:79], v13 offset:4608
    v_mfma_f32_16x16x32_bf16 v[96:99], v[16:19], v[72:75], v[96:99]
    ds_read_b128 v[40:43], v12 offset:0
    v_mfma_f32_16x16x32_bf16 v[100:103], v[64:67], v[20:23], v[100:103]
    ds_read_b64_tr_b16 v[80:81], v13 offset:12288
    v_mfma_f32_16x16x32_bf16 v[104:107], v[68:71], v[20:23], v[104:107]
    ds_read_b64_tr_b16 v[82:83], v13 offset:12800
    v_mfma_f32_16x16x32_bf16 v[108:111], v[20:23], v[72:75], v[108:111]
    ds_read_b64_tr_b16 v[84:85], v13 offset:20480
    v_mfma_f32_16x16x32_bf16 v[112:115], v[64:67], v[24:27], v[112:115]
    ds_read_b64_tr_b16 v[86:87], v13 offset:20992
    v_mfma_f32_16x16x32_bf16 v[116:119], v[68:71], v[24:27], v[116:119]
    ds_read_b128 v[44:47], v12 offset:2048
    v_mfma_f32_16x16x32_bf16 v[120:123], v[24:27], v[72:75], v[120:123]
    ds_read_b128 v[48:51], v12 offset:4096
    v_mfma_f32_16x16x32_bf16 v[124:127], v[64:67], v[28:31], v[124:127]
    ds_read_b128 v[52:55], v12 offset:6144
    v_mfma_f32_16x16x32_bf16 v[128:131], v[68:71], v[28:31], v[128:131]
    ds_read_b128 v[56:59], v12 offset:8192
    v_mfma_f32_16x16x32_bf16 v[132:135], v[28:31], v[72:75], v[132:135]
    ds_read_b128 v[60:63], v12 offset:10240
    v_mfma_f32_16x16x32_bf16 v[136:139], v[64:67], v[32:35], v[136:139]
    v_mfma_f32_16x16x32_bf16 v[140:143], v[68:71], v[32:35], v[140:143]
    v_mfma_f32_16x16x32_bf16 v[144:147], v[32:35], v[72:75], v[144:147]
    v_mfma_f32_16x16x32_bf16 v[148:151], v[64:67], v[36:39], v[148:151]
    v_mfma_f32_16x16x32_bf16 v[152:155], v[68:71], v[36:39], v[152:155]
    v_mfma_f32_16x16x32_bf16 v[156:159], v[36:39], v[72:75], v[156:159]
    s_waitcnt lgkmcnt(0)
    s_barrier
    v_mfma_f32_16x16x32_bf16 v[88:91], v[76:79], v[40:43], v[88:91]
    ds_read_b64_tr_b16 v[64:65], v13 offset:24576
    v_mfma_f32_16x16x32_bf16 v[92:95], v[80:83], v[40:43], v[92:95]
    ds_read_b64_tr_b16 v[66:67], v13 offset:25088
    v_mfma_f32_16x16x32_bf16 v[96:99], v[40:43], v[84:87], v[96:99]
    ds_read_b128 v[16:19], v11 offset:12288
    v_mfma_f32_16x16x32_bf16 v[100:103], v[76:79], v[44:47], v[100:103]
    ds_read_b64_tr_b16 v[68:69], v13 offset:32768
    v_mfma_f32_16x16x32_bf16 v[104:107], v[80:83], v[44:47], v[104:107]
    ds_read_b64_tr_b16 v[70:71], v13 offset:33280
    v_mfma_f32_16x16x32_bf16 v[108:111], v[44:47], v[84:87], v[108:111]
    ds_read_b64_tr_b16 v[72:73], v13 offset:40960
    v_mfma_f32_16x16x32_bf16 v[112:115], v[76:79], v[48:51], v[112:115]
    ds_read_b64_tr_b16 v[74:75], v13 offset:41472
    v_mfma_f32_16x16x32_bf16 v[116:119], v[80:83], v[48:51], v[116:119]
    ds_read_b128 v[20:23], v11 offset:14336
    v_mfma_f32_16x16x32_bf16 v[120:123], v[48:51], v[84:87], v[120:123]
    ds_read_b128 v[24:27], v11 offset:16384
    v_mfma_f32_16x16x32_bf16 v[124:127], v[76:79], v[52:55], v[124:127]
    ds_read_b128 v[28:31], v11 offset:18432
    v_mfma_f32_16x16x32_bf16 v[128:131], v[80:83], v[52:55], v[128:131]
    ds_read_b128 v[32:35], v11 offset:20480
    v_mfma_f32_16x16x32_bf16 v[132:135], v[52:55], v[84:87], v[132:135]
    ds_read_b128 v[36:39], v11 offset:22528
    v_mfma_f32_16x16x32_bf16 v[136:139], v[76:79], v[56:59], v[136:139]
    v_mfma_f32_16x16x32_bf16 v[140:143], v[80:83], v[56:59], v[140:143]
    v_mfma_f32_16x16x32_bf16 v[144:147], v[56:59], v[84:87], v[144:147]
    v_mfma_f32_16x16x32_bf16 v[148:151], v[76:79], v[60:63], v[148:151]
    v_mfma_f32_16x16x32_bf16 v[152:155], v[80:83], v[60:63], v[152:155]
    v_mfma_f32_16x16x32_bf16 v[156:159], v[60:63], v[84:87], v[156:159]
    s_waitcnt lgkmcnt(0)
    s_nop 0
    v_mfma_f32_16x16x32_bf16 v[88:91], v[64:67], v[16:19], v[88:91]
    ds_read_b64_tr_b16 v[76:77], v13 offset:28672
    v_mfma_f32_16x16x32_bf16 v[92:95], v[68:71], v[16:19], v[92:95]
    ds_read_b64_tr_b16 v[78:79], v13 offset:29184
    v_mfma_f32_16x16x32_bf16 v[96:99], v[16:19], v[72:75], v[96:99]
    ds_read_b128 v[40:43], v12 offset:12288
    v_mfma_f32_16x16x32_bf16 v[100:103], v[64:67], v[20:23], v[100:103]
    ds_read_b64_tr_b16 v[80:81], v13 offset:36864
    v_mfma_f32_16x16x32_bf16 v[104:107], v[68:71], v[20:23], v[104:107]
    ds_read_b64_tr_b16 v[82:83], v13 offset:37376
    v_mfma_f32_16x16x32_bf16 v[108:111], v[20:23], v[72:75], v[108:111]
    ds_read_b64_tr_b16 v[84:85], v13 offset:45056
    v_mfma_f32_16x16x32_bf16 v[112:115], v[64:67], v[24:27], v[112:115]
    ds_read_b64_tr_b16 v[86:87], v13 offset:45568
    v_mfma_f32_16x16x32_bf16 v[116:119], v[68:71], v[24:27], v[116:119]
    ds_read_b128 v[44:47], v12 offset:14336
    v_mfma_f32_16x16x32_bf16 v[120:123], v[24:27], v[72:75], v[120:123]
    ds_read_b128 v[48:51], v12 offset:16384
    v_mfma_f32_16x16x32_bf16 v[124:127], v[64:67], v[28:31], v[124:127]
    ds_read_b128 v[52:55], v12 offset:18432
    v_mfma_f32_16x16x32_bf16 v[128:131], v[68:71], v[28:31], v[128:131]
    ds_read_b128 v[56:59], v12 offset:20480
    v_mfma_f32_16x16x32_bf16 v[132:135], v[28:31], v[72:75], v[132:135]
    ds_read_b128 v[60:63], v12 offset:22528
    v_mfma_f32_16x16x32_bf16 v[136:139], v[64:67], v[32:35], v[136:139]
    v_mfma_f32_16x16x32_bf16 v[140:143], v[68:71], v[32:35], v[140:143]
    v_mfma_f32_16x16x32_bf16 v[144:147], v[32:35], v[72:75], v[144:147]
    v_mfma_f32_16x16x32_bf16 v[148:151], v[64:67], v[36:39], v[148:151]
    v_mfma_f32_16x16x32_bf16 v[152:155], v[68:71], v[36:39], v[152:155]
    v_mfma_f32_16x16x32_bf16 v[156:159], v[36:39], v[72:75], v[156:159]
    s_waitcnt lgkmcnt(0)
    s_barrier
    v_mfma_f32_16x16x32_bf16 v[88:91], v[76:79], v[40:43], v[88:91]
    ds_read_b64_tr_b16 v[64:65], v14 offset:0
    v_mfma_f32_16x16x32_bf16 v[92:95], v[80:83], v[40:43], v[92:95]
    ds_read_b64_tr_b16 v[66:67], v14 offset:512
    v_mfma_f32_16x16x32_bf16 v[96:99], v[40:43], v[84:87], v[96:99]
    ds_read_b128 v[16:19], v11 offset:24576
    v_mfma_f32_16x16x32_bf16 v[100:103], v[76:79], v[44:47], v[100:103]
    ds_read_b64_tr_b16 v[68:69], v14 offset:8192
    v_mfma_f32_16x16x32_bf16 v[104:107], v[80:83], v[44:47], v[104:107]
    ds_read_b64_tr_b16 v[70:71], v14 offset:8704
    v_mfma_f32_16x16x32_bf16 v[108:111], v[44:47], v[84:87], v[108:111]
    ds_read_b64_tr_b16 v[72:73], v14 offset:16384
    v_mfma_f32_16x16x32_bf16 v[112:115], v[76:79], v[48:51], v[112:115]
    ds_read_b64_tr_b16 v[74:75], v14 offset:16896
    v_mfma_f32_16x16x32_bf16 v[116:119], v[80:83], v[48:51], v[116:119]
    ds_read_b128 v[20:23], v11 offset:26624
    v_mfma_f32_16x16x32_bf16 v[120:123], v[48:51], v[84:87], v[120:123]
    ds_read_b128 v[24:27], v11 offset:28672
    v_mfma_f32_16x16x32_bf16 v[124:127], v[76:79], v[52:55], v[124:127]
    ds_read_b128 v[28:31], v11 offset:30720
    v_mfma_f32_16x16x32_bf16 v[128:131], v[80:83], v[52:55], v[128:131]
    ds_read_b128 v[32:35], v11 offset:32768
    v_mfma_f32_16x16x32_bf16 v[132:135], v[52:55], v[84:87], v[132:135]
    ds_read_b128 v[36:39], v11 offset:34816
    v_mfma_f32_16x16x32_bf16 v[136:139], v[76:79], v[56:59], v[136:139]
    v_mfma_f32_16x16x32_bf16 v[140:143], v[80:83], v[56:59], v[140:143]
    v_mfma_f32_16x16x32_bf16 v[144:147], v[56:59], v[84:87], v[144:147]
    v_mfma_f32_16x16x32_bf16 v[148:151], v[76:79], v[60:63], v[148:151]
    v_mfma_f32_16x16x32_bf16 v[152:155], v[80:83], v[60:63], v[152:155]
    v_mfma_f32_16x16x32_bf16 v[156:159], v[60:63], v[84:87], v[156:159]
    s_waitcnt lgkmcnt(0)
    s_nop 0
    v_mfma_f32_16x16x32_bf16 v[88:91], v[64:67], v[16:19], v[88:91]
    ds_read_b64_tr_b16 v[76:77], v14 offset:4096
    v_mfma_f32_16x16x32_bf16 v[92:95], v[68:71], v[16:19], v[92:95]
    ds_read_b64_tr_b16 v[78:79], v14 offset:4608
    v_mfma_f32_16x16x32_bf16 v[96:99], v[16:19], v[72:75], v[96:99]
    ds_read_b128 v[40:43], v12 offset:24576
    v_mfma_f32_16x16x32_bf16 v[100:103], v[64:67], v[20:23], v[100:103]
    ds_read_b64_tr_b16 v[80:81], v14 offset:12288
    v_mfma_f32_16x16x32_bf16 v[104:107], v[68:71], v[20:23], v[104:107]
    ds_read_b64_tr_b16 v[82:83], v14 offset:12800
    v_mfma_f32_16x16x32_bf16 v[108:111], v[20:23], v[72:75], v[108:111]
    ds_read_b64_tr_b16 v[84:85], v14 offset:20480
    v_mfma_f32_16x16x32_bf16 v[112:115], v[64:67], v[24:27], v[112:115]
    ds_read_b64_tr_b16 v[86:87], v14 offset:20992
    v_mfma_f32_16x16x32_bf16 v[116:119], v[68:71], v[24:27], v[116:119]
    ds_read_b128 v[44:47], v12 offset:26624
    v_mfma_f32_16x16x32_bf16 v[120:123], v[24:27], v[72:75], v[120:123]
    ds_read_b128 v[48:51], v12 offset:28672
    v_mfma_f32_16x16x32_bf16 v[124:127], v[64:67], v[28:31], v[124:127]
    ds_read_b128 v[52:55], v12 offset:30720
    v_mfma_f32_16x16x32_bf16 v[128:131], v[68:71], v[28:31], v[128:131]
    ds_read_b128 v[56:59], v12 offset:32768
    v_mfma_f32_16x16x32_bf16 v[132:135], v[28:31], v[72:75], v[132:135]
    ds_read_b128 v[60:63], v12 offset:34816
    v_mfma_f32_16x16x32_bf16 v[136:139], v[64:67], v[32:35], v[136:139]
    v_mfma_f32_16x16x32_bf16 v[140:143], v[68:71], v[32:35], v[140:143]
    v_mfma_f32_16x16x32_bf16 v[144:147], v[32:35], v[72:75], v[144:147]
    v_mfma_f32_16x16x32_bf16 v[148:151], v[64:67], v[36:39], v[148:151]
    v_mfma_f32_16x16x32_bf16 v[152:155], v[68:71], v[36:39], v[152:155]
    v_mfma_f32_16x16x32_bf16 v[156:159], v[36:39], v[72:75], v[156:159]
    s_waitcnt lgkmcnt(0)
    s_barrier
    v_mfma_f32_16x16x32_bf16 v[88:91], v[76:79], v[40:43], v[88:91]
    ds_read_b64_tr_b16 v[64:65], v14 offset:24576
    v_mfma_f32_16x16x32_bf16 v[92:95], v[80:83], v[40:43], v[92:95]
    ds_read_b64_tr_b16 v[66:67], v14 offset:25088
    v_mfma_f32_16x16x32_bf16 v[96:99], v[40:43], v[84:87], v[96:99]
    ds_read_b128 v[16:19], v11 offset:36864
    v_mfma_f32_16x16x32_bf16 v[100:103], v[76:79], v[44:47], v[100:103]
    ds_read_b64_tr_b16 v[68:69], v14 offset:32768
    v_mfma_f32_16x16x32_bf16 v[104:107], v[80:83], v[44:47], v[104:107]
    ds_read_b64_tr_b16 v[70:71], v14 offset:33280
    v_mfma_f32_16x16x32_bf16 v[108:111], v[44:47], v[84:87], v[108:111]
    ds_read_b64_tr_b16 v[72:73], v14 offset:40960
    v_mfma_f32_16x16x32_bf16 v[112:115], v[76:79], v[48:51], v[112:115]
    ds_read_b64_tr_b16 v[74:75], v14 offset:41472
    v_mfma_f32_16x16x32_bf16 v[116:119], v[80:83], v[48:51], v[116:119]
    ds_read_b128 v[20:23], v11 offset:38912
    v_mfma_f32_16x16x32_bf16 v[120:123], v[48:51], v[84:87], v[120:123]
    ds_read_b128 v[24:27], v11 offset:40960
    v_mfma_f32_16x16x32_bf16 v[124:127], v[76:79], v[52:55], v[124:127]
    ds_read_b128 v[28:31], v11 offset:43008
    v_mfma_f32_16x16x32_bf16 v[128:131], v[80:83], v[52:55], v[128:131]
    ds_read_b128 v[32:35], v11 offset:45056
    v_mfma_f32_16x16x32_bf16 v[132:135], v[52:55], v[84:87], v[132:135]
    ds_read_b128 v[36:39], v11 offset:47104
    v_mfma_f32_16x16x32_bf16 v[136:139], v[76:79], v[56:59], v[136:139]
    v_mfma_f32_16x16x32_bf16 v[140:143], v[80:83], v[56:59], v[140:143]
    v_mfma_f32_16x16x32_bf16 v[144:147], v[56:59], v[84:87], v[144:147]
    v_mfma_f32_16x16x32_bf16 v[148:151], v[76:79], v[60:63], v[148:151]
    v_mfma_f32_16x16x32_bf16 v[152:155], v[80:83], v[60:63], v[152:155]
    v_mfma_f32_16x16x32_bf16 v[156:159], v[60:63], v[84:87], v[156:159]
    s_waitcnt lgkmcnt(0)
    s_nop 0
    v_mfma_f32_16x16x32_bf16 v[88:91], v[64:67], v[16:19], v[88:91]
    ds_read_b64_tr_b16 v[76:77], v14 offset:28672
    v_mfma_f32_16x16x32_bf16 v[92:95], v[68:71], v[16:19], v[92:95]
    ds_read_b64_tr_b16 v[78:79], v14 offset:29184
    v_mfma_f32_16x16x32_bf16 v[96:99], v[16:19], v[72:75], v[96:99]
    ds_read_b128 v[40:43], v12 offset:36864
    v_mfma_f32_16x16x32_bf16 v[100:103], v[64:67], v[20:23], v[100:103]
    ds_read_b64_tr_b16 v[80:81], v14 offset:36864
    v_mfma_f32_16x16x32_bf16 v[104:107], v[68:71], v[20:23], v[104:107]
    ds_read_b64_tr_b16 v[82:83], v14 offset:37376
    v_mfma_f32_16x16x32_bf16 v[108:111], v[20:23], v[72:75], v[108:111]
    ds_read_b64_tr_b16 v[84:85], v14 offset:45056
    v_mfma_f32_16x16x32_bf16 v[112:115], v[64:67], v[24:27], v[112:115]
    ds_read_b64_tr_b16 v[86:87], v14 offset:45568
    v_mfma_f32_16x16x32_bf16 v[116:119], v[68:71], v[24:27], v[116:119]
    ds_read_b128 v[44:47], v12 offset:38912
    v_mfma_f32_16x16x32_bf16 v[120:123], v[24:27], v[72:75], v[120:123]
    ds_read_b128 v[48:51], v12 offset:40960
    v_mfma_f32_16x16x32_bf16 v[124:127], v[64:67], v[28:31], v[124:127]
    ds_read_b128 v[52:55], v12 offset:43008
    v_mfma_f32_16x16x32_bf16 v[128:131], v[68:71], v[28:31], v[128:131]
    ds_read_b128 v[56:59], v12 offset:45056
    v_mfma_f32_16x16x32_bf16 v[132:135], v[28:31], v[72:75], v[132:135]
    ds_read_b128 v[60:63], v12 offset:47104
    v_mfma_f32_16x16x32_bf16 v[136:139], v[64:67], v[32:35], v[136:139]
    v_mfma_f32_16x16x32_bf16 v[140:143], v[68:71], v[32:35], v[140:143]
    v_mfma_f32_16x16x32_bf16 v[144:147], v[32:35], v[72:75], v[144:147]
    v_mfma_f32_16x16x32_bf16 v[148:151], v[64:67], v[36:39], v[148:151]
    v_mfma_f32_16x16x32_bf16 v[152:155], v[68:71], v[36:39], v[152:155]
    v_mfma_f32_16x16x32_bf16 v[156:159], v[36:39], v[72:75], v[156:159]
    s_waitcnt lgkmcnt(0)
    s_barrier
    v_mfma_f32_16x16x32_bf16 v[88:91], v[76:79], v[40:43], v[88:91]
    ds_read_b64_tr_b16 v[64:65], v13 offset:0
    v_mfma_f32_16x16x32_bf16 v[92:95], v[80:83], v[40:43], v[92:95]
    ds_read_b64_tr_b16 v[66:67], v13 offset:512
    v_mfma_f32_16x16x32_bf16 v[96:99], v[40:43], v[84:87], v[96:99]
    ds_read_b128 v[16:19], v11 offset:0
    v_mfma_f32_16x16x32_bf16 v[100:103], v[76:79], v[44:47], v[100:103]
    ds_read_b64_tr_b16 v[68:69], v13 offset:8192
    v_mfma_f32_16x16x32_bf16 v[104:107], v[80:83], v[44:47], v[104:107]
    ds_read_b64_tr_b16 v[70:71], v13 offset:8704
    v_mfma_f32_16x16x32_bf16 v[108:111], v[44:47], v[84:87], v[108:111]
    ds_read_b64_tr_b16 v[72:73], v13 offset:16384
    v_mfma_f32_16x16x32_bf16 v[112:115], v[76:79], v[48:51], v[112:115]
    ds_read_b64_tr_b16 v[74:75], v13 offset:16896
    v_mfma_f32_16x16x32_bf16 v[116:119], v[80:83], v[48:51], v[116:119]
    ds_read_b128 v[20:23], v11 offset:2048
    v_mfma_f32_16x16x32_bf16 v[120:123], v[48:51], v[84:87], v[120:123]
    ds_read_b128 v[24:27], v11 offset:4096
    v_mfma_f32_16x16x32_bf16 v[124:127], v[76:79], v[52:55], v[124:127]
    ds_read_b128 v[28:31], v11 offset:6144
    v_mfma_f32_16x16x32_bf16 v[128:131], v[80:83], v[52:55], v[128:131]
    ds_read_b128 v[32:35], v11 offset:8192
    v_mfma_f32_16x16x32_bf16 v[132:135], v[52:55], v[84:87], v[132:135]
    ds_read_b128 v[36:39], v11 offset:10240
    v_mfma_f32_16x16x32_bf16 v[136:139], v[76:79], v[56:59], v[136:139]
    v_mfma_f32_16x16x32_bf16 v[140:143], v[80:83], v[56:59], v[140:143]
    v_mfma_f32_16x16x32_bf16 v[144:147], v[56:59], v[84:87], v[144:147]
    v_mfma_f32_16x16x32_bf16 v[148:151], v[76:79], v[60:63], v[148:151]
    v_mfma_f32_16x16x32_bf16 v[152:155], v[80:83], v[60:63], v[152:155]
    v_mfma_f32_16x16x32_bf16 v[156:159], v[60:63], v[84:87], v[156:159]
    s_waitcnt lgkmcnt(0)
    s_nop 0
    v_mfma_f32_16x16x32_bf16 v[88:91], v[64:67], v[16:19], v[88:91]
    ds_read_b64_tr_b16 v[76:77], v13 offset:4096
    v_mfma_f32_16x16x32_bf16 v[92:95], v[68:71], v[16:19], v[92:95]
    ds_read_b64_tr_b16 v[78:79], v13 offset:4608
    v_mfma_f32_16x16x32_bf16 v[96:99], v[16:19], v[72:75], v[96:99]
    ds_read_b128 v[40:43], v12 offset:0
    v_mfma_f32_16x16x32_bf16 v[100:103], v[64:67], v[20:23], v[100:103]
    ds_read_b64_tr_b16 v[80:81], v13 offset:12288
    v_mfma_f32_16x16x32_bf16 v[104:107], v[68:71], v[20:23], v[104:107]
    ds_read_b64_tr_b16 v[82:83], v13 offset:12800
    v_mfma_f32_16x16x32_bf16 v[108:111], v[20:23], v[72:75], v[108:111]
    ds_read_b64_tr_b16 v[84:85], v13 offset:20480
    v_mfma_f32_16x16x32_bf16 v[112:115], v[64:67], v[24:27], v[112:115]
    ds_read_b64_tr_b16 v[86:87], v13 offset:20992
    v_mfma_f32_16x16x32_bf16 v[116:119], v[68:71], v[24:27], v[116:119]
    ds_read_b128 v[44:47], v12 offset:2048
    v_mfma_f32_16x16x32_bf16 v[120:123], v[24:27], v[72:75], v[120:123]
    ds_read_b128 v[48:51], v12 offset:4096
    v_mfma_f32_16x16x32_bf16 v[124:127], v[64:67], v[28:31], v[124:127]
    ds_read_b128 v[52:55], v12 offset:6144
    v_mfma_f32_16x16x32_bf16 v[128:131], v[68:71], v[28:31], v[128:131]
    ds_read_b128 v[56:59], v12 offset:8192
    v_mfma_f32_16x16x32_bf16 v[132:135], v[28:31], v[72:75], v[132:135]
    ds_read_b128 v[60:63], v12 offset:10240
    v_mfma_f32_16x16x32_bf16 v[136:139], v[64:67], v[32:35], v[136:139]
    v_mfma_f32_16x16x32_bf16 v[140:143], v[68:71], v[32:35], v[140:143]
    v_mfma_f32_16x16x32_bf16 v[144:147], v[32:35], v[72:75], v[144:147]
    v_mfma_f32_16x16x32_bf16 v[148:151], v[64:67], v[36:39], v[148:151]
    v_mfma_f32_16x16x32_bf16 v[152:155], v[68:71], v[36:39], v[152:155]
    v_mfma_f32_16x16x32_bf16 v[156:159], v[36:39], v[72:75], v[156:159]
    s_waitcnt vmcnt(0) lgkmcnt(0)
    s_nop 0
    v_mfma_f32_16x16x32_bf16 v[148:151], v[76:79], v[60:63], v[148:151]
    v_mov_b32 v186, 0
    v_mov_b32 v187, 0
    v_mfma_f32_16x16x32_bf16 v[136:139], v[76:79], v[56:59], v[136:139]
    v_mfma_f32_16x16x32_bf16 v[124:127], v[76:79], v[52:55], v[124:127]
    v_mfma_f32_16x16x32_bf16 v[92:95], v[80:83], v[40:43], v[92:95]
    s_nop 2
    v_cvt_pk_bf16_f32 v26, v148, v149
    v_mfma_f32_16x16x32_bf16 v[100:103], v[76:79], v[44:47], v[100:103]
    v_cvt_pk_bf16_f32 v27, v150, v151
    v_cvt_pk_bf16_f32 v25, v138, v139
    v_mfma_f32_16x16x32_bf16 v[104:107], v[80:83], v[44:47], v[104:107]
    v_cvt_pk_bf16_f32 v24, v136, v137
    v_cvt_pk_bf16_f32 v22, v124, v125
    v_mfma_f32_16x16x32_bf16 v[112:115], v[76:79], v[48:51], v[112:115]
    v_cvt_pk_bf16_f32 v23, v126, v127
    v_cvt_pk_bf16_f32 v29, v94, v95
    v_mfma_f32_16x16x32_bf16 v[116:119], v[80:83], v[48:51], v[116:119]
    v_cvt_pk_bf16_f32 v28, v92, v93
    v_cvt_pk_bf16_f32 v18, v100, v101
    v_mfma_f32_16x16x32_bf16 v[128:131], v[80:83], v[52:55], v[128:131]
    v_cvt_pk_bf16_f32 v19, v102, v103
    v_cvt_pk_bf16_f32 v30, v104, v105
    v_mfma_f32_16x16x32_bf16 v[140:143], v[80:83], v[56:59], v[140:143]
    v_cvt_pk_bf16_f32 v31, v106, v107
    v_cvt_pk_bf16_f32 v21, v114, v115
    v_mfma_f32_16x16x32_bf16 v[88:91], v[76:79], v[40:43], v[88:91]
    v_cvt_pk_bf16_f32 v20, v112, v113
    v_cvt_pk_bf16_f32 v32, v116, v117
    v_mfma_f32_16x16x32_bf16 v[152:155], v[80:83], v[60:63], v[152:155]
    v_cvt_pk_bf16_f32 v33, v118, v119
    v_cvt_pk_bf16_f32 v34, v128, v129
    v_cvt_pk_bf16_f32 v35, v130, v131
    v_mfma_f32_16x16x16_bf16 v[100:103], v[30:31], v[18:19], v[160:163]
    v_cvt_pk_bf16_f32 v36, v140, v141
    v_cvt_pk_bf16_f32 v37, v142, v143
    v_mfma_f32_16x16x16_bf16 v[104:107], v[28:29], v[18:19], v[164:167]
    v_cvt_pk_bf16_f32 v16, v88, v89
    v_cvt_pk_bf16_f32 v17, v90, v91
    v_mfma_f32_16x16x16_bf16 v[112:115], v[32:33], v[20:21], v[160:163]
    v_cvt_pk_bf16_f32 v38, v152, v153
    v_cvt_pk_bf16_f32 v39, v154, v155
    v_mfma_f32_16x16x16_bf16 v[116:119], v[30:31], v[20:21], v[164:167]
    v_mfma_f32_16x16x16_bf16 v[124:127], v[34:35], v[22:23], v[160:163]
    s_nop 0
    v_max_f32 v100, v100, v104
    v_mfma_f32_16x16x16_bf16 v[128:131], v[32:33], v[22:23], v[164:167]
    v_max_f32 v101, v101, v105
    v_max_f32 v102, v102, v106
    v_mfma_f32_16x16x16_bf16 v[140:143], v[34:35], v[24:25], v[164:167]
    v_max_f32 v103, v103, v107
    v_max3_f32 v210, v100, v101, v102
    v_mfma_f32_16x16x16_bf16 v[148:151], v[38:39], v[26:27], v[160:163]
    v_max_f32 v112, v112, v116
    v_max_f32 v113, v113, v117
    v_mfma_f32_16x16x16_bf16 v[136:139], v[36:37], v[24:25], v[160:163]
    v_max_f32 v114, v114, v118
    v_max_f32 v126, v126, v130
    v_max_f32 v124, v124, v128
    v_mfma_f32_16x16x16_bf16 v[88:91], v[28:29], v[16:17], v[160:163]
    v_max_f32 v125, v125, v129
    v_max_f32 v115, v115, v119
    v_max3_f32 v212, v112, v113, v114
    v_max_f32 v127, v127, v131
    v_max3_f32 v214, v124, v125, v126
    v_mfma_f32_16x16x16_bf16 v[152:155], v[36:37], v[26:27], v[164:167]
    v_max_f32 v210, v210, v103
    v_max_f32 v136, v136, v140
    v_max_f32 v137, v137, v141
    v_max_f32 v138, v138, v142
    v_max_f32 v139, v139, v143
    v_max_f32 v212, v212, v115
    v_max3_f32 v208, v88, v89, v90
    v_max3_f32 v216, v136, v137, v138
    v_max_f32 v214, v214, v127
    v_mfma_f32_16x16x32_bf16 v[96:99], v[40:43], v[84:87], v[96:99]
    v_max_f32 v208, v208, v91
    v_max_f32 v216, v216, v139
    v_max_f32 v148, v148, v152
    v_max_f32 v149, v149, v153
    v_max_f32 v150, v150, v154
    v_permlane32_swap_b32 v208, v210
    v_max_f32 v151, v151, v155
    v_max3_f32 v218, v148, v149, v150
    v_max_f32 v208, v208, v210
    v_permlane32_swap_b32 v212, v214
    v_max_f32 v218, v218, v151
    v_mov_b32 v210, v208
    v_max_f32 v212, v212, v214
    v_mfma_f32_16x16x32_bf16 v[108:111], v[44:47], v[84:87], v[108:111]
    v_permlane32_swap_b32 v216, v218
    v_permlane16_swap_b32 v208, v210
    v_max_f32 v216, v216, v218
    v_mov_b32 v214, v212
    v_max_f32 v208, v208, v210
    v_mfma_f32_16x16x32_bf16 v[120:123], v[48:51], v[84:87], v[120:123]
    v_mov_b32 v218, v216
    v_permlane16_swap_b32 v212, v214
    v_mul_f32 v208, s94, v208
    v_permlane16_swap_b32 v216, v218
    v_max_f32 v212, v212, v214
    v_mov_b32 v210, v208
    v_max_f32 v216, v216, v218
    v_mfma_f32_16x16x32_bf16 v[132:135], v[52:55], v[84:87], v[132:135]
    v_mul_f32 v212, s94, v212
    v_mul_f32 v216, s94, v216
    v_permlane32_swap_b32 v208, v210
    v_mov_b32 v214, v212
    v_mov_b32 v218, v216
    v_pk_fma_f32 v[100:101], v[100:101], s[94:95], v[210:211] op_sel_hi:[1,1,0] neg_lo:[0,0,1] neg_hi:[0,0,1]
    v_pk_fma_f32 v[102:103], v[102:103], s[94:95], v[210:211] op_sel_hi:[1,1,0] neg_lo:[0,0,1] neg_hi:[0,0,1]
    v_permlane32_swap_b32 v212, v214
    v_permlane32_swap_b32 v216, v218
    v_pk_fma_f32 v[112:113], v[112:113], s[94:95], v[212:213] op_sel_hi:[1,1,0] neg_lo:[0,0,1] neg_hi:[0,0,1]
    v_pk_fma_f32 v[114:115], v[114:115], s[94:95], v[212:213] op_sel_hi:[1,1,0] neg_lo:[0,0,1] neg_hi:[0,0,1]
    v_pk_fma_f32 v[124:125], v[124:125], s[94:95], v[214:215] op_sel_hi:[1,1,0] neg_lo:[0,0,1] neg_hi:[0,0,1]
    v_pk_fma_f32 v[126:127], v[126:127], s[94:95], v[214:215] op_sel_hi:[1,1,0] neg_lo:[0,0,1] neg_hi:[0,0,1]
    v_exp_f32 v112, v112
    v_pk_fma_f32 v[136:137], v[136:137], s[94:95], v[216:217] op_sel_hi:[1,1,0] neg_lo:[0,0,1] neg_hi:[0,0,1]
    v_exp_f32 v127, v127
    v_pk_fma_f32 v[138:139], v[138:139], s[94:95], v[216:217] op_sel_hi:[1,1,0] neg_lo:[0,0,1] neg_hi:[0,0,1]
    v_pk_fma_f32 v[148:149], v[148:149], s[94:95], v[218:219] op_sel_hi:[1,1,0] neg_lo:[0,0,1] neg_hi:[0,0,1]
    v_pk_fma_f32 v[150:151], v[150:151], s[94:95], v[218:219] op_sel_hi:[1,1,0] neg_lo:[0,0,1] neg_hi:[0,0,1]
    v_exp_f32 v102, v102
    v_exp_f32 v149, v149
    v_exp_f32 v151, v151
    v_exp_f32 v100, v100
    v_exp_f32 v113, v113
    v_exp_f32 v114, v114
    v_exp_f32 v115, v115
    v_exp_f32 v124, v124
    v_exp_f32 v125, v125
    v_exp_f32 v126, v126
    v_exp_f32 v136, v136
    v_exp_f32 v137, v137
    v_exp_f32 v138, v138
    v_exp_f32 v139, v139
    v_exp_f32 v150, v150
    v_cvt_pk_bf16_f32 v200, v136, v137
    v_cvt_pk_bf16_f32 v192, v112, v113
    v_pk_fma_f32 v[88:89], v[88:89], s[94:95], v[208:209] op_sel_hi:[1,1,0] neg_lo:[0,0,1] neg_hi:[0,0,1]
    v_cvt_pk_bf16_f32 v201, v138, v139
    v_pk_fma_f32 v[90:91], v[90:91], s[94:95], v[208:209] op_sel_hi:[1,1,0] neg_lo:[0,0,1] neg_hi:[0,0,1]
    v_exp_f32 v103, v103
    v_exp_f32 v148, v148
    v_mfma_f32_16x16x32_bf16 v[144:147], v[56:59], v[84:87], v[144:147]
    v_cvt_pk_bf16_f32 v193, v114, v115
    v_cvt_pk_bf16_f32 v189, v102, v103
    v_mfma_f32_16x16x32_bf16 v[156:159], v[60:63], v[84:87], v[156:159]
    v_cvt_pk_bf16_f32 v196, v124, v125
    v_cvt_pk_bf16_f32 v197, v126, v127
    v_cvt_pk_bf16_f32 v204, v148, v149
    v_cvt_pk_bf16_f32 v205, v150, v151
    v_exp_f32 v88, v88
    v_exp_f32 v90, v90
    v_and_b32 v207, v205, v169
    v_and_b32 v191, v189, v169
    v_and_b32 v194, v192, v168
    v_and_b32 v195, v193, v169
    v_and_b32 v198, v196, v168
    v_and_b32 v199, v197, v169
    v_and_b32 v202, v200, v168
    v_and_b32 v203, v201, v169
    v_and_b32 v206, v204, v168
    v_exp_f32 v101, v101
    v_xor_b32 v189, v189, v191
    v_xor_b32 v192, v192, v194
    v_xor_b32 v193, v193, v195
    v_xor_b32 v196, v196, v198
    v_xor_b32 v197, v197, v199
    v_cvt_pk_bf16_f32 v188, v100, v101
    v_xor_b32 v200, v200, v202
    v_xor_b32 v201, v201, v203
    v_xor_b32 v204, v204, v206
    v_and_b32 v190, v188, v168
    v_xor_b32 v205, v205, v207
    v_exp_f32 v91, v91
    v_xor_b32 v188, v188, v190
    v_mfma_f32_16x16x32_bf16 v[116:119], v[172:175], v[192:195], 0
    v_cvt_pk_bf16_f32 v65, v98, v99
    v_cvt_pk_bf16_f32 v66, v108, v109
    v_cvt_pk_bf16_f32 v185, v90, v91
    v_mfma_f32_16x16x32_bf16 v[104:107], v[172:175], v[188:191], 0
    v_cvt_pk_bf16_f32 v67, v110, v111
    v_cvt_pk_bf16_f32 v68, v120, v121
    v_mfma_f32_16x16x32_bf16 v[128:131], v[172:175], v[196:199], 0
    v_cvt_pk_bf16_f32 v69, v122, v123
    v_cvt_pk_bf16_f32 v71, v134, v135
    v_mfma_f32_16x16x32_bf16 v[140:143], v[172:175], v[200:203], 0
    v_cvt_pk_bf16_f32 v72, v144, v145
    v_cvt_pk_bf16_f32 v73, v146, v147
    v_mfma_f32_16x16x32_bf16 v[152:155], v[172:175], v[204:207], 0
    v_cvt_pk_bf16_f32 v74, v156, v157
    v_cvt_pk_bf16_f32 v75, v158, v159
    v_exp_f32 v89, v89
    v_cvt_pk_bf16_f32 v64, v96, v97
    v_mfma_f32_16x16x32_bf16 v[120:123], v[66:69], v[192:195], 0
    v_rcp_f32 v210, v104
    v_cvt_pk_bf16_f32 v184, v88, v89
    v_mfma_f32_16x16x32_bf16 v[108:111], v[64:67], v[188:191], 0
    v_rcp_f32 v214, v128
    v_mfma_f32_16x16x32_bf16 v[92:95], v[172:175], v[184:187], 0
    v_rcp_f32 v218, v152
    v_mfma_f32_16x16x32_bf16 v[96:99], v[64:67], v[184:187], 0
    v_rcp_f32 v212, v116
    v_mfma_f32_16x16x32_bf16 v[156:159], v[72:75], v[204:207], 0
    v_rcp_f32 v216, v140
    v_cvt_pk_bf16_f32 v70, v132, v133
    v_pk_mul_f32 v[108:109], v[108:109], v[210:211] op_sel_hi:[1,0]
    v_pk_mul_f32 v[110:111], v[110:111], v[210:211] op_sel_hi:[1,0]
    v_rcp_f32 v208, v92
    v_mfma_f32_16x16x32_bf16 v[132:135], v[68:71], v[196:199], 0
    v_cvt_pk_bf16_f32 v18, v108, v109
    v_cvt_pk_bf16_f32 v19, v110, v111
    v_mfma_f32_16x16x32_bf16 v[144:147], v[70:73], v[200:203], 0
    ds_write_b64 v176, v[18:19] offset:14336
    v_pk_mul_f32 v[96:97], v[96:97], v[208:209] op_sel_hi:[1,0]
    v_pk_mul_f32 v[98:99], v[98:99], v[208:209] op_sel_hi:[1,0]
    v_pk_mul_f32 v[120:121], v[120:121], v[212:213] op_sel_hi:[1,0]
    v_pk_mul_f32 v[122:123], v[122:123], v[212:213] op_sel_hi:[1,0]
    v_pk_mul_f32 v[156:157], v[156:157], v[218:219] op_sel_hi:[1,0]
    v_pk_mul_f32 v[158:159], v[158:159], v[218:219] op_sel_hi:[1,0]
    v_cvt_pk_bf16_f32 v16, v96, v97
    v_pk_mul_f32 v[132:133], v[132:133], v[214:215] op_sel_hi:[1,0]
    v_pk_mul_f32 v[134:135], v[134:135], v[214:215] op_sel_hi:[1,0]
    v_cvt_pk_bf16_f32 v21, v122, v123
    v_cvt_pk_bf16_f32 v20, v120, v121
    v_pk_mul_f32 v[144:145], v[144:145], v[216:217] op_sel_hi:[1,0]
    v_pk_mul_f32 v[146:147], v[146:147], v[216:217] op_sel_hi:[1,0]
    v_cvt_pk_bf16_f32 v22, v132, v133
    v_cvt_pk_bf16_f32 v26, v156, v157
    v_cvt_pk_bf16_f32 v24, v144, v145
    v_cvt_pk_bf16_f32 v25, v146, v147
    v_cvt_pk_bf16_f32 v27, v158, v159
    v_cvt_pk_bf16_f32 v23, v134, v135
    v_cvt_pk_bf16_f32 v17, v98, v99
    ds_write_b64 v176, v[20:21] offset:16384
    ds_write_b64 v176, v[24:25] offset:20480
    ds_write_b64 v176, v[22:23] offset:18432
    ds_write_b64 v176, v[16:17] offset:12288
    ds_write_b64 v176, v[26:27] offset:22528
    s_waitcnt lgkmcnt(0)
    s_barrier
    ds_read_b128 v[28:31], v177 offset:12288
    ds_read_b128 v[32:35], v177 offset:13312
    ds_read_b128 v[36:39], v177 offset:14336
    s_waitcnt lgkmcnt(2)
    buffer_store_dwordx4 v[28:31], v178, s[60:63], 0 offen sc1
    s_waitcnt lgkmcnt(1)
    buffer_store_dwordx4 v[32:35], v179, s[60:63], 0 offen sc1
    s_waitcnt lgkmcnt(0)
    buffer_store_dwordx4 v[36:39], v180, s[60:63], 0 offen sc1
K_P2C:
    v_xor_b32 v209, 32, v3
    v_xor_b32 v210, 64, v3
    v_xor_b32 v211, 96, v3
    s_waitcnt vmcnt(0)
    s_barrier
K_RD:
    ds_read_b64_tr_b16 v[80:81], v8 offset:0
    ds_read_b64_tr_b16 v[82:83], v8 offset:512
    ds_read_b64_tr_b16 v[84:85], v8 offset:2048
    ds_read_b64_tr_b16 v[86:87], v8 offset:2560
    ds_read_b64_tr_b16 v[88:89], v8 offset:4096
    ds_read_b64_tr_b16 v[90:91], v8 offset:4608
    ds_read_b64_tr_b16 v[92:93], v8 offset:6144
    ds_read_b64_tr_b16 v[94:95], v8 offset:6656
    ds_read_b64_tr_b16 v[96:97], v8 offset:8192
    ds_read_b64_tr_b16 v[98:99], v8 offset:8704
    ds_read_b64_tr_b16 v[100:101], v8 offset:10240
    ds_read_b64_tr_b16 v[102:103], v8 offset:10752
    ds_read_b64_tr_b16 v[104:105], v8 offset:12288
    ds_read_b64_tr_b16 v[106:107], v8 offset:12800
    ds_read_b64_tr_b16 v[108:109], v8 offset:14336
    ds_read_b64_tr_b16 v[110:111], v8 offset:14848
    ds_read_b64_tr_b16 v[112:113], v8 offset:16384
    ds_read_b64_tr_b16 v[114:115], v8 offset:16896
    ds_read_b64_tr_b16 v[116:117], v8 offset:18432
    ds_read_b64_tr_b16 v[118:119], v8 offset:18944
    ds_read_b64_tr_b16 v[120:121], v8 offset:20480
    ds_read_b64_tr_b16 v[122:123], v8 offset:20992
    ds_read_b64_tr_b16 v[124:125], v8 offset:22528
    ds_read_b64_tr_b16 v[126:127], v8 offset:23040
    ds_read_b64_tr_b16 v[128:129], v8 offset:24576
    ds_read_b64_tr_b16 v[130:131], v8 offset:25088
    ds_read_b64_tr_b16 v[132:133], v8 offset:26624
    ds_read_b64_tr_b16 v[134:135], v8 offset:27136
    ds_read_b64_tr_b16 v[136:137], v8 offset:28672
    ds_read_b64_tr_b16 v[138:139], v8 offset:29184
    ds_read_b64_tr_b16 v[140:141], v8 offset:30720
    ds_read_b64_tr_b16 v[142:143], v8 offset:31232
    ds_read_b64_tr_b16 v[144:145], v8 offset:32768
    ds_read_b64_tr_b16 v[146:147], v8 offset:33280
    ds_read_b64_tr_b16 v[148:149], v8 offset:34816
    ds_read_b64_tr_b16 v[150:151], v8 offset:35328
    ds_read_b64_tr_b16 v[152:153], v8 offset:36864
    ds_read_b64_tr_b16 v[154:155], v8 offset:37376
    ds_read_b64_tr_b16 v[156:157], v8 offset:38912
    ds_read_b64_tr_b16 v[158:159], v8 offset:39424
    ds_read_b64_tr_b16 v[160:161], v8 offset:40960
    ds_read_b64_tr_b16 v[162:163], v8 offset:41472
    ds_read_b64_tr_b16 v[164:165], v8 offset:43008
    ds_read_b64_tr_b16 v[166:167], v8 offset:43520
    ds_read_b64_tr_b16 v[168:169], v8 offset:45056
    ds_read_b64_tr_b16 v[170:171], v8 offset:45568
    ds_read_b64_tr_b16 v[172:173], v8 offset:47104
    ds_read_b64_tr_b16 v[174:175], v8 offset:47616
    ds_read_b64_tr_b16 v[176:177], v8 offset:49152
    ds_read_b64_tr_b16 v[178:179], v8 offset:49664
    ds_read_b64_tr_b16 v[180:181], v8 offset:51200
    ds_read_b64_tr_b16 v[182:183], v8 offset:51712
    ds_read_b64_tr_b16 v[184:185], v8 offset:53248
    ds_read_b64_tr_b16 v[186:187], v8 offset:53760
    ds_read_b64_tr_b16 v[188:189], v8 offset:55296
    ds_read_b64_tr_b16 v[190:191], v8 offset:55808
    ds_read_b64_tr_b16 v[192:193], v8 offset:57344
    ds_read_b64_tr_b16 v[194:195], v8 offset:57856
    ds_read_b64_tr_b16 v[196:197], v8 offset:59392
    ds_read_b64_tr_b16 v[198:199], v8 offset:59904
    ds_read_b64_tr_b16 v[200:201], v8 offset:61440
    ds_read_b64_tr_b16 v[202:203], v8 offset:61952
    ds_read_b64_tr_b16 v[204:205], v8 offset:63488
    ds_read_b64_tr_b16 v[206:207], v8 offset:64000
    s_waitcnt lgkmcnt(0)
    s_cmp_lt_u32 s5, 8
    s_cbranch_scc1 K_RDC
K_RDB:
    s_mov_b32 s76, 4456448
    s_barrier
    s_barrier
    ds_read_b128 v[48:51], v4 offset:0
    ds_read_b128 v[52:55], v4 offset:2048
    ds_read_b128 v[56:59], v4 offset:4096
    ds_read_b128 v[60:63], v4 offset:6144
    ds_read_b128 v[64:67], v4 offset:8192
    ds_read_b128 v[68:71], v4 offset:10240
    ds_read_b128 v[72:75], v4 offset:12288
    ds_read_b128 v[76:79], v4 offset:14336
    s_waitcnt lgkmcnt(7)
    v_mfma_f32_32x32x16_bf16 v[16:31], v[48:51], v[220:223], 0
    s_waitcnt lgkmcnt(6)
    v_mfma_f32_32x32x16_bf16 v[16:31], v[52:55], v[224:227], v[16:31]
    s_waitcnt lgkmcnt(5)
    v_mfma_f32_32x32x16_bf16 v[16:31], v[56:59], v[228:231], v[16:31]
    s_waitcnt lgkmcnt(4)
    v_mfma_f32_32x32x16_bf16 v[16:31], v[60:63], v[232:235], v[16:31]
    s_waitcnt lgkmcnt(3)
    v_mfma_f32_32x32x16_bf16 v[16:31], v[64:67], v[236:239], v[16:31]
    s_waitcnt lgkmcnt(2)
    v_mfma_f32_32x32x16_bf16 v[16:31], v[68:71], v[240:243], v[16:31]
    s_waitcnt lgkmcnt(1)
    v_mfma_f32_32x32x16_bf16 v[16:31], v[72:75], v[244:247], v[16:31]
    s_waitcnt lgkmcnt(0)
    v_mfma_f32_32x32x16_bf16 v[16:31], v[76:79], v[248:251], v[16:31]
    s_cmp_lt_u32 s5, 8
    s_cbranch_scc1 K_RD
K_RDC:
    s_barrier
    buffer_load_dword v212, v2, s[60:63], s76 offen sc1
    s_barrier
    ds_read_b128 v[48:51], v3 offset:0
    ds_read_b128 v[52:55], v209 offset:0
    ds_read_b128 v[56:59], v210 offset:0
    ds_read_b128 v[60:63], v211 offset:0
    s_waitcnt lgkmcnt(0)
    v_mfma_f32_32x32x16_bf16 v[32:47], v[80:83], v[48:51], 0
    s_barrier
    ds_read_b128 v[64:67], v3 offset:8192
    ds_read_b128 v[68:71], v209 offset:8192
    v_mfma_f32_32x32x16_bf16 v[32:47], v[84:87], v[52:55], v[32:47]
    ds_read_b128 v[72:75], v210 offset:8192
    ds_read_b128 v[76:79], v211 offset:8192
    v_mfma_f32_32x32x16_bf16 v[32:47], v[88:91], v[56:59], v[32:47]
    v_mfma_f32_32x32x16_bf16 v[32:47], v[92:95], v[60:63], v[32:47]
    s_waitcnt lgkmcnt(0)
    v_mfma_f32_32x32x16_bf16 v[32:47], v[96:99], v[64:67], v[32:47]
    s_barrier
    ds_read_b128 v[48:51], v3 offset:16384
    ds_read_b128 v[52:55], v209 offset:16384
    v_mfma_f32_32x32x16_bf16 v[32:47], v[100:103], v[68:71], v[32:47]
    ds_read_b128 v[56:59], v210 offset:16384
    ds_read_b128 v[60:63], v211 offset:16384
    v_mfma_f32_32x32x16_bf16 v[32:47], v[104:107], v[72:75], v[32:47]
    v_mfma_f32_32x32x16_bf16 v[32:47], v[108:111], v[76:79], v[32:47]
    s_waitcnt lgkmcnt(0)
    v_mfma_f32_32x32x16_bf16 v[32:47], v[112:115], v[48:51], v[32:47]
    s_barrier
    ds_read_b128 v[64:67], v3 offset:24576
    ds_read_b128 v[68:71], v209 offset:24576
    v_mfma_f32_32x32x16_bf16 v[32:47], v[116:119], v[52:55], v[32:47]
    ds_read_b128 v[72:75], v210 offset:24576
    ds_read_b128 v[76:79], v211 offset:24576
    v_mfma_f32_32x32x16_bf16 v[32:47], v[120:123], v[56:59], v[32:47]
    v_mfma_f32_32x32x16_bf16 v[32:47], v[124:127], v[60:63], v[32:47]
    s_waitcnt lgkmcnt(0)
    v_mfma_f32_32x32x16_bf16 v[32:47], v[128:131], v[64:67], v[32:47]
    s_barrier
    ds_read_b128 v[48:51], v3 offset:32768
    ds_read_b128 v[52:55], v209 offset:32768
    v_mfma_f32_32x32x16_bf16 v[32:47], v[132:135], v[68:71], v[32:47]
    ds_read_b128 v[56:59], v210 offset:32768
    ds_read_b128 v[60:63], v211 offset:32768
    v_mfma_f32_32x32x16_bf16 v[32:47], v[136:139], v[72:75], v[32:47]
    v_mfma_f32_32x32x16_bf16 v[32:47], v[140:143], v[76:79], v[32:47]
    s_waitcnt lgkmcnt(0)
    v_mfma_f32_32x32x16_bf16 v[32:47], v[144:147], v[48:51], v[32:47]
    s_barrier
    ds_read_b128 v[64:67], v3 offset:40960
    ds_read_b128 v[68:71], v209 offset:40960
    s_waitcnt vmcnt(0)
    v_sub_f32 v214, 1.0, v212
    v_add_u32 v208, 524288, v7
    v_mfma_f32_32x32x16_bf16 v[32:47], v[148:151], v[52:55], v[32:47]
    ds_read_b128 v[72:75], v210 offset:40960
    ds_read_b128 v[76:79], v211 offset:40960
    v_mfma_f32_32x32x16_bf16 v[32:47], v[152:155], v[56:59], v[32:47]
    v_mfma_f32_32x32x16_bf16 v[32:47], v[156:159], v[60:63], v[32:47]
    s_waitcnt lgkmcnt(0)
    v_mfma_f32_32x32x16_bf16 v[32:47], v[160:163], v[64:67], v[32:47]
    s_barrier
    ds_read_b128 v[48:51], v3 offset:49152
    ds_read_b128 v[52:55], v209 offset:49152
    v_mul_f32 v16, v16, v212
    v_mul_f32 v17, v17, v212
    v_mfma_f32_32x32x16_bf16 v[32:47], v[164:167], v[68:71], v[32:47]
    ds_read_b128 v[56:59], v210 offset:49152
    ds_read_b128 v[60:63], v211 offset:49152
    v_mul_f32 v18, v18, v212
    v_mul_f32 v19, v19, v212
    v_mfma_f32_32x32x16_bf16 v[32:47], v[168:171], v[72:75], v[32:47]
    v_mul_f32 v20, v20, v212
    v_mul_f32 v21, v21, v212
    v_mfma_f32_32x32x16_bf16 v[32:47], v[172:175], v[76:79], v[32:47]
    v_mul_f32 v22, v22, v212
    v_mul_f32 v23, v23, v212
    s_waitcnt lgkmcnt(0)
    v_mfma_f32_32x32x16_bf16 v[32:47], v[176:179], v[48:51], v[32:47]
    s_barrier
    ds_read_b128 v[64:67], v3 offset:57344
    ds_read_b128 v[68:71], v209 offset:57344
    v_mul_f32 v24, v24, v212
    v_mul_f32 v25, v25, v212
    v_mfma_f32_32x32x16_bf16 v[32:47], v[180:183], v[52:55], v[32:47]
    ds_read_b128 v[72:75], v210 offset:57344
    ds_read_b128 v[76:79], v211 offset:57344
    v_mul_f32 v26, v26, v212
    v_mul_f32 v27, v27, v212
    v_mfma_f32_32x32x16_bf16 v[32:47], v[184:187], v[56:59], v[32:47]
    v_mul_f32 v28, v28, v212
    v_mul_f32 v29, v29, v212
    v_mfma_f32_32x32x16_bf16 v[32:47], v[188:191], v[60:63], v[32:47]
    v_mul_f32 v30, v30, v212
    v_mul_f32 v31, v31, v212
    s_waitcnt lgkmcnt(3)
    v_mfma_f32_32x32x16_bf16 v[32:47], v[192:195], v[64:67], v[32:47]
    s_waitcnt lgkmcnt(2)
    v_mfma_f32_32x32x16_bf16 v[32:47], v[196:199], v[68:71], v[32:47]
    s_waitcnt lgkmcnt(1)
    v_mfma_f32_32x32x16_bf16 v[32:47], v[200:203], v[72:75], v[32:47]
    s_waitcnt lgkmcnt(0)
    v_mfma_f32_32x32x16_bf16 v[32:47], v[204:207], v[76:79], v[32:47]
    v_xor_b32 v217, 16, v5
    v_xor_b32 v218, 32, v5
    v_xor_b32 v219, 48, v5
    s_nop 8
    v_pk_fma_f32 v[32:33], v[32:33], v[214:215], v[16:17] op_sel_hi:[1,0,1]
    v_pk_fma_f32 v[34:35], v[34:35], v[214:215], v[18:19] op_sel_hi:[1,0,1]
    v_cvt_pk_bf16_f32 v80, v32, v33
    v_cvt_pk_bf16_f32 v81, v34, v35
    ds_write_b64 v5, v[80:81]
    v_pk_fma_f32 v[36:37], v[36:37], v[214:215], v[20:21] op_sel_hi:[1,0,1]
    v_pk_fma_f32 v[38:39], v[38:39], v[214:215], v[22:23] op_sel_hi:[1,0,1]
    v_cvt_pk_bf16_f32 v82, v36, v37
    v_cvt_pk_bf16_f32 v83, v38, v39
    ds_write_b64 v217, v[82:83]
    v_pk_fma_f32 v[40:41], v[40:41], v[214:215], v[24:25] op_sel_hi:[1,0,1]
    v_pk_fma_f32 v[42:43], v[42:43], v[214:215], v[26:27] op_sel_hi:[1,0,1]
    v_cvt_pk_bf16_f32 v84, v40, v41
    v_cvt_pk_bf16_f32 v85, v42, v43
    ds_write_b64 v218, v[84:85]
    v_pk_fma_f32 v[44:45], v[44:45], v[214:215], v[28:29] op_sel_hi:[1,0,1]
    v_pk_fma_f32 v[46:47], v[46:47], v[214:215], v[30:31] op_sel_hi:[1,0,1]
    v_cvt_pk_bf16_f32 v86, v44, v45
    v_cvt_pk_bf16_f32 v87, v46, v47
    ds_write_b64 v219, v[86:87]
    ds_read_b128 v[88:91], v6 offset:0
    ds_read_b128 v[92:95], v6 offset:1024
    s_waitcnt lgkmcnt(1)
    buffer_store_dwordx4 v[88:91], v7, s[72:75], 0 offen sc1
    s_waitcnt lgkmcnt(0)
    buffer_store_dwordx4 v[92:95], v208, s[72:75], 0 offen sc1
K_END:
    s_endpgm
CODE_END:
.section .rodata,"a"
.p2align 6
.amdhsa_kernel gated_mix__spectral_fnet__sliding_local_dilated__prompt_kernel
  .amdhsa_next_free_vgpr 256
  .amdhsa_next_free_sgpr 102
  .amdhsa_accum_offset 256
  .amdhsa_group_segment_fixed_size 0
  .amdhsa_kernarg_size 96
  .amdhsa_user_sgpr_count 2
  .amdhsa_user_sgpr_kernarg_segment_ptr 1
  .amdhsa_system_sgpr_workgroup_id_x 1
.end_amdhsa_kernel
```
